```python
import torch

def _softmax(x, axis=-1):
    return torch.softmax(x, dim=axis)
def _gelu(x):
    return torch.nn.functional.gelu(x, approximate="tanh")
def _silu(x):
    return torch.nn.functional.silu(x)
def _sigmoid(x):
    return torch.sigmoid(x)
def _layernorm(x, axis=-1, eps=1e-5):
    m = x.mean(dim=axis, keepdim=True)
    v = x.var(dim=axis, keepdim=True, unbiased=False)
    return (x - m) / torch.sqrt(v + eps)
def _scatter_add(tgt, idx, src, axis=0):
    return tgt.clone().index_add_(axis, idx, src)
def _segment_sum(src, seg, n):
    out = torch.zeros((n,) + src.shape[1:], dtype=src.dtype)
    return out.index_add_(0, seg, src)
def _pad(x, pw):
    flat = tuple(v for pair in reversed(pw) for v in pair)
    return torch.nn.functional.pad(x, flat)

kernel_name = 'concat_heads__softmax_full_mha__softmax_full_mha__prompt'

def setup_inputs():

    _w = (lambda a: (lambda t: t.to(torch.bfloat16) if t.is_floating_point() else t)(torch.as_tensor(a)))
    def _A_setup():
        B, S, D = 1, 2048, 512
        return {
            "x": _w((lambda *s: torch.randn(*s, dtype=torch.bfloat16) * 0.2)(B, S, D)),
            "wqkv": _w((lambda *s: torch.randn(*s, dtype=torch.bfloat16) * 0.2)(D, 3 * D)),
            "wo": _w((lambda *s: torch.randn(*s, dtype=torch.bfloat16) * 0.05)(D, D)),
        }
    _A_in = _A_setup()

    def _B_setup():
        B, S, D = 1, 2048, 512
        return {
            "x": _w((lambda *s: torch.randn(*s, dtype=torch.bfloat16) * 0.2)(B, S, D)),
            "wqkv": _w((lambda *s: torch.randn(*s, dtype=torch.bfloat16) * 0.2)(D, 3 * D)),
            "wo": _w((lambda *s: torch.randn(*s, dtype=torch.bfloat16) * 0.05)(D, D)),
        }
    _B_in = _B_setup()

    return {
        "A_x": _A_in["x"],
        "A_wqkv": _A_in["wqkv"],
        "A_wo": _A_in["wo"],
        "B_x": _B_in["x"],
        "B_wqkv": _B_in["wqkv"],
        "B_wo": _B_in["wo"],
    }

def reference(A_x, A_wqkv, A_wo, B_x, B_wqkv, B_wo):
    def _A_ref(x, wqkv, wo):
        B, S, D = x.shape
        H = 32; Dh = D // H
        qkv = (lambda x, *d: x.permute(*d))((x @ wqkv).reshape(B, S, 3, H, Dh), 2, 0, 3, 1, 4)
        q, k, v = qkv[0], qkv[1], qkv[2]
        scale = Dh ** -0.5
        scores = torch.einsum("bhqd,bhkd->bhqk", q, k) * scale
        p = _softmax(scores, axis=-1)
        o = torch.einsum("bhqk,bhkd->bhqd", p, v)
        return (lambda x, *d: x.permute(*d))(o, 0, 2, 1, 3).reshape(B, S, D) @ wo

    def _B_ref(x, wqkv, wo):
        B, S, D = x.shape
        H = 32; Dh = D // H
        qkv = (lambda x, *d: x.permute(*d))((x @ wqkv).reshape(B, S, 3, H, Dh), 2, 0, 3, 1, 4)
        q, k, v = qkv[0], qkv[1], qkv[2]
        scale = Dh ** -0.5
        scores = torch.einsum("bhqd,bhkd->bhqk", q, k) * scale
        p = _softmax(scores, axis=-1)
        o = torch.einsum("bhqk,bhkd->bhqd", p, v)
        return (lambda x, *d: x.permute(*d))(o, 0, 2, 1, 3).reshape(B, S, D) @ wo

    a = _A_ref(A_x, A_wqkv, A_wo)
    b = _B_ref(B_x, B_wqkv, B_wo)
    return torch.concatenate([a, b], axis=-1)
```

```asm
; @launch grid=(256,1,1) block=(576,1,1) lds=163840
.amdgcn_target "amdgcn-amd-amdhsa--gfx950"
.text
.globl concat_heads__softmax_full_mha__softmax_full_mha__prompt_kernel
.p2align 8
.type concat_heads__softmax_full_mha__softmax_full_mha__prompt_kernel,@function
concat_heads__softmax_full_mha__softmax_full_mha__prompt_kernel:
    s_load_dwordx16 s[36:51], s[0:1], 0
    s_load_dwordx2 s[8:9], s[0:1], 64
    s_cmp_ge_u32 s2, 256
    s_cbranch_scc1 .L_end
    v_lshrrev_b32 v1, 6, v0
    v_and_b32 v2, 63, v0
    s_bfe_u32 s22, s2, 0x10002
    v_readfirstlane_b32 s27, v1
    s_and_b32 s25, s2, 1
    s_lshl_b32 s25, s25, 3
    s_lshr_b32 s21, s2, 5
    s_add_u32 s25, s25, s21
    s_bfe_u32 s24, s2, 0x10001
    s_lshl_b32 s24, s24, 2
    s_bfe_u32 s21, s2, 0x20003
    s_add_u32 s24, s24, s21
    s_lshl_b32 s26, s22, 4
    s_add_u32 s26, s26, s25
    s_cmp_lt_u32 s27, 4
    s_cbranch_scc1 .L_p1c
    s_cmp_eq_u32 s27, 8
    s_cbranch_scc1 .L_helper
    s_sub_u32 s28, s27, 4
    v_lshrrev_b32 v3, 3, v2
    v_and_b32 v4, 7, v2
    v_lshrrev_b32 v5, 4, v2
    v_xor_b32 v6, v5, v4
    v_lshlrev_b32 v6, 4, v6
    v_lshl_add_u32 v8, v3, 10, v6
    v_xor_b32 v6, 64, v8
    v_add_u32 v9, 7168, v6
    v_add_u32 v10, 14336, v8
    v_add_u32 v11, 21504, v6
    v_lshrrev_b32 v3, 2, v2
    v_and_b32 v4, 3, v2
    v_mul_u32_u24 v3, 3072, v3
    v_lshl_add_u32 v12, v4, 4, v3
    s_lshl_b32 s30, s24, 8
    s_lshl_b32 s31, s28, 6
    s_add_u32 s30, s30, s31
    s_lshl_b32 s30, s30, 10
    s_mul_i32 s31, s28, 49152
    s_lshl_b32 s32, s25, 6
    s_add_u32 s31, s31, s32
    s_lshl_b32 s33, s28, 13
    s_mul_i32 s34, s28, 3072
    s_add_u32 s34, s34, 32768
    s_sub_u32 s34, s34, s33
    s_mov_b32 s35, 0
    s_mov_b32 s29, 0
    s_brev_b32 s23, s2
    s_lshr_b32 s23, s23, 29
    s_add_u32 s56, s24, s25
    s_and_b32 s56, s56, 3
    s_lshl_b32 s56, s56, 1
    s_min_u32 s56, s56, 6
    s_mov_b32 s57, s30
    s_mov_b32 s58, s31
    s_lshl_b32 s20, s23, 7
    s_add_u32 s30, s57, s20
    s_mul_i32 s20, s23, 196608
    s_add_u32 s31, s58, s20
    s_mov_b32 s18, 2097152
    s_mov_b32 s19, 0x00020000
    s_mov_b32 s6, 1572864
    s_mov_b32 s7, 0x00020000
    s_cmp_eq_u32 s22, 0
    s_waitcnt lgkmcnt(0)
    s_cselect_b32 s16, s36, s42
    s_cselect_b32 s17, s37, s43
    s_cselect_b32 s4, s38, s44
    s_cselect_b32 s5, s39, s45
.L_p1l_loop:
    s_mov_b32 m0, s33
    s_add_u32 s20, s30, 32768
    buffer_load_dwordx4 v8, s[16:19], s30 offen offset:0 lds
    buffer_load_dwordx4 v9, s[16:19], s30 offen offset:1024 lds
    buffer_load_dwordx4 v10, s[16:19], s30 offen offset:2048 lds
    buffer_load_dwordx4 v11, s[16:19], s30 offen offset:3072 lds
    s_add_u32 m0, s33, s34
    s_add_u32 s30, s30, 128
    buffer_load_dwordx4 v12, s[4:7], s31 offen offset:0 lds
    buffer_load_dwordx4 v12, s[4:7], s31 offen offset:1024 lds
    buffer_load_dwordx4 v12, s[4:7], s31 offen offset:2048 lds
    s_add_u32 m0, s33, 4096
    s_add_u32 s31, s31, 196608
    buffer_load_dwordx4 v8, s[16:19], s20 offen offset:0 lds
    buffer_load_dwordx4 v9, s[16:19], s20 offen offset:1024 lds
    buffer_load_dwordx4 v10, s[16:19], s20 offen offset:2048 lds
    buffer_load_dwordx4 v11, s[16:19], s20 offen offset:3072 lds
    s_add_u32 s33, s33, 45056
    s_add_u32 s29, s29, 1
    s_cmp_eq_u32 s29, 3
    s_cbranch_scc0 .L_p1l_nowrap
    s_mov_b32 s29, 0
    s_sub_u32 s33, s33, 135168
.L_p1l_nowrap:
    s_add_u32 s20, s23, s56
    s_add_u32 s20, s20, 1
    s_and_b32 s20, s20, 7
    s_lshl_b32 s21, s20, 7
    s_add_u32 s30, s57, s21
    s_mul_i32 s21, s20, 196608
    s_add_u32 s31, s58, s21
    s_add_u32 s56, s56, 1
    s_cmp_eq_u32 s56, 7
    s_cselect_b32 s56, 0, s56
    s_add_u32 s35, s35, 1
    s_cmp_le_u32 s35, 1
    s_cbranch_scc1 .L_p1l_loop
    s_waitcnt vmcnt(11)
    s_barrier
    s_cmp_lt_u32 s35, 8
    s_cbranch_scc1 .L_p1l_loop
    s_waitcnt vmcnt(0)
    s_barrier
    s_mov_b32 s12, s8
    s_mov_b32 s13, s9
    s_mov_b32 s14, 13631488
    s_mov_b32 s15, 0x00020000
    s_branch .L_setup
.L_p1c:
    v_and_b32 v3, 31, v2
    v_lshrrev_b32 v9, 5, v2
    v_bfe_u32 v10, v3, 1, 3
    s_lshl_b32 s30, s27, 13
    v_lshlrev_b32 v11, 7, v3
    v_add_u32 v11, s30, v11
    v_add_u32 v1, 0, v9
    v_xor_b32 v1, v1, v10
    v_lshl_add_u32 v4, v1, 4, v11
    v_add_u32 v1, 2, v9
    v_xor_b32 v1, v1, v10
    v_lshl_add_u32 v5, v1, 4, v11
    v_add_u32 v1, 4, v9
    v_xor_b32 v1, v1, v10
    v_lshl_add_u32 v6, v1, 4, v11
    v_add_u32 v1, 6, v9
    v_xor_b32 v1, v1, v10
    v_lshl_add_u32 v7, v1, 4, v11
    v_bfe_u32 v10, v2, 2, 2
    v_lshl_add_u32 v11, v9, 3, v10
    v_lshlrev_b32 v11, 6, v11
    v_bfe_u32 v1, v2, 4, 1
    v_lshl_add_u32 v11, v1, 5, v11
    v_and_b32 v1, 3, v2
    v_lshl_add_u32 v8, v1, 3, v11
    s_mov_b32 s35, 0
    s_mov_b32 s29, 0
    s_lshl_b32 s56, s26, 7
    s_lshl_b32 s57, s24, 3
    s_add_u32 s56, s56, s57
    s_lshl_b32 s57, s27, 1
    s_add_u32 s56, s56, s57
    s_lshl_b32 s56, s56, 10
    s_add_u32 s57, s56, 0x10000
    s_add_u32 s58, s56, 4194304
    s_mov_b32 s60, 0x3eb8aa3b
    s_mov_b32 s61, 0x3eb8aa3b
    v_and_b32 v148, 0x13, v3
    v_bfe_u32 v1, v3, 2, 1
    v_lshl_or_b32 v148, v1, 3, v148
    v_bfe_u32 v1, v3, 3, 1
    v_lshl_or_b32 v148, v1, 2, v148
    v_lshlrev_b32 v148, 4, v148
    v_lshl_add_u32 v148, v9, 9, v148
    s_lshl_b32 s20, s27, 11
    v_add_u32 v149, s20, v148
    v_and_b32 v150, 15, v2
    v_lshlrev_b32 v150, 4, v150
    v_lshl_add_u32 v150, v9, 8, v150
    v_bfe_u32 v1, v2, 4, 1
    v_mul_u32_u24 v151, 8192, v1
    v_add_u32 v151, v151, v150
    s_mul_i32 s21, s27, 2048
    s_add_u32 s21, s21, 16384
    v_add_u32 v151, s21, v151
    v_lshl_add_u32 v150, v1, 16, v150
    v_lshlrev_b32 v3, 4, v2
    v_add_u32 v10, s20, v3
    v_add_u32 v10, 135168, v10
    v_mov_b32 v52, 0
    v_mov_b32 v53, 0
    v_mov_b32 v54, 0
    v_mov_b32 v55, 0
    v_mov_b32 v56, 0
    v_mov_b32 v57, 0
    v_mov_b32 v58, 0
    v_mov_b32 v59, 0
    v_mov_b32 v60, 0
    v_mov_b32 v61, 0
    v_mov_b32 v62, 0
    v_mov_b32 v63, 0
    v_mov_b32 v64, 0
    v_mov_b32 v65, 0
    v_mov_b32 v66, 0
    v_mov_b32 v67, 0
    v_mov_b32 v68, 0
    v_mov_b32 v69, 0
    v_mov_b32 v70, 0
    v_mov_b32 v71, 0
    v_mov_b32 v72, 0
    v_mov_b32 v73, 0
    v_mov_b32 v74, 0
    v_mov_b32 v75, 0
    v_mov_b32 v76, 0
    v_mov_b32 v77, 0
    v_mov_b32 v78, 0
    v_mov_b32 v79, 0
    v_mov_b32 v80, 0
    v_mov_b32 v81, 0
    v_mov_b32 v82, 0
    v_mov_b32 v83, 0
    v_mov_b32 v84, 0
    v_mov_b32 v85, 0
    v_mov_b32 v86, 0
    v_mov_b32 v87, 0
    v_mov_b32 v88, 0
    v_mov_b32 v89, 0
    v_mov_b32 v90, 0
    v_mov_b32 v91, 0
    v_mov_b32 v92, 0
    v_mov_b32 v93, 0
    v_mov_b32 v94, 0
    v_mov_b32 v95, 0
    v_mov_b32 v96, 0
    v_mov_b32 v97, 0
    v_mov_b32 v98, 0
    v_mov_b32 v99, 0
    v_mov_b32 v100, 0
    v_mov_b32 v101, 0
    v_mov_b32 v102, 0
    v_mov_b32 v103, 0
    v_mov_b32 v104, 0
    v_mov_b32 v105, 0
    v_mov_b32 v106, 0
    v_mov_b32 v107, 0
    v_mov_b32 v108, 0
    v_mov_b32 v109, 0
    v_mov_b32 v110, 0
    v_mov_b32 v111, 0
    v_mov_b32 v112, 0
    v_mov_b32 v113, 0
    v_mov_b32 v114, 0
    v_mov_b32 v115, 0
    v_mov_b32 v116, 0
    v_mov_b32 v117, 0
    v_mov_b32 v118, 0
    v_mov_b32 v119, 0
    v_mov_b32 v120, 0
    v_mov_b32 v121, 0
    v_mov_b32 v122, 0
    v_mov_b32 v123, 0
    v_mov_b32 v124, 0
    v_mov_b32 v125, 0
    v_mov_b32 v126, 0
    v_mov_b32 v127, 0
    v_mov_b32 v128, 0
    v_mov_b32 v129, 0
    v_mov_b32 v130, 0
    v_mov_b32 v131, 0
    v_mov_b32 v132, 0
    v_mov_b32 v133, 0
    v_mov_b32 v134, 0
    v_mov_b32 v135, 0
    v_mov_b32 v136, 0
    v_mov_b32 v137, 0
    v_mov_b32 v138, 0
    v_mov_b32 v139, 0
    v_mov_b32 v140, 0
    v_mov_b32 v141, 0
    v_mov_b32 v142, 0
    v_mov_b32 v143, 0
    v_mov_b32 v144, 0
    v_mov_b32 v145, 0
    v_mov_b32 v146, 0
    v_mov_b32 v147, 0
    s_waitcnt lgkmcnt(0)
    s_mov_b32 s12, s8
    s_mov_b32 s13, s9
    s_mov_b32 s14, 13631488
    s_mov_b32 s15, 0x00020000
    s_barrier
    ds_read_b128 v[12:15], v4 offset:0
    ds_read_b64_tr_b16 v[20:21], v8 offset:32768
    ds_read_b64_tr_b16 v[22:23], v8 offset:33024
    ds_read_b64_tr_b16 v[24:25], v8 offset:33792
    ds_read_b64_tr_b16 v[26:27], v8 offset:34048
    ds_read_b64_tr_b16 v[28:29], v8 offset:34816
    ds_read_b64_tr_b16 v[30:31], v8 offset:35072
    ds_read_b128 v[16:19], v4 offset:4096
.L_p1c_loop:
    s_waitcnt lgkmcnt(0)
    v_mfma_f32_32x32x16_bf16 v[52:67], v[20:23], v[12:15], v[52:67]
    ds_read_b128 v[32:35], v5 offset:0
    ds_read_b64_tr_b16 v[40:41], v8 offset:35840
    v_mfma_f32_32x32x16_bf16 v[84:99], v[24:27], v[12:15], v[84:99]
    ds_read_b64_tr_b16 v[42:43], v8 offset:36096
    ds_read_b64_tr_b16 v[44:45], v8 offset:36864
    v_mfma_f32_32x32x16_bf16 v[116:131], v[12:15], v[28:31], v[116:131]
    ds_read_b64_tr_b16 v[46:47], v8 offset:37120
    ds_read_b64_tr_b16 v[48:49], v8 offset:37888
    v_mfma_f32_32x32x16_bf16 v[68:83], v[20:23], v[16:19], v[68:83]
    ds_read_b64_tr_b16 v[50:51], v8 offset:38144
    ds_read_b128 v[36:39], v5 offset:4096
    v_mfma_f32_32x32x16_bf16 v[100:115], v[24:27], v[16:19], v[100:115]
    v_mfma_f32_32x32x16_bf16 v[132:147], v[16:19], v[28:31], v[132:147]
    s_waitcnt lgkmcnt(0)
    v_mfma_f32_32x32x16_bf16 v[52:67], v[40:43], v[32:35], v[52:67]
    ds_read_b128 v[12:15], v6 offset:0
    ds_read_b64_tr_b16 v[20:21], v8 offset:38912
    v_mfma_f32_32x32x16_bf16 v[84:99], v[44:47], v[32:35], v[84:99]
    ds_read_b64_tr_b16 v[22:23], v8 offset:39168
    ds_read_b64_tr_b16 v[24:25], v8 offset:39936
    v_mfma_f32_32x32x16_bf16 v[116:131], v[32:35], v[48:51], v[116:131]
    ds_read_b64_tr_b16 v[26:27], v8 offset:40192
    ds_read_b64_tr_b16 v[28:29], v8 offset:40960
    v_mfma_f32_32x32x16_bf16 v[68:83], v[40:43], v[36:39], v[68:83]
    ds_read_b64_tr_b16 v[30:31], v8 offset:41216
    ds_read_b128 v[16:19], v6 offset:4096
    v_mfma_f32_32x32x16_bf16 v[100:115], v[44:47], v[36:39], v[100:115]
    v_mfma_f32_32x32x16_bf16 v[132:147], v[36:39], v[48:51], v[132:147]
    s_waitcnt lgkmcnt(0)
    v_mfma_f32_32x32x16_bf16 v[52:67], v[20:23], v[12:15], v[52:67]
    ds_read_b128 v[32:35], v7 offset:0
    ds_read_b64_tr_b16 v[40:41], v8 offset:41984
    v_mfma_f32_32x32x16_bf16 v[84:99], v[24:27], v[12:15], v[84:99]
    ds_read_b64_tr_b16 v[42:43], v8 offset:42240
    ds_read_b64_tr_b16 v[44:45], v8 offset:43008
    v_mfma_f32_32x32x16_bf16 v[116:131], v[12:15], v[28:31], v[116:131]
    ds_read_b64_tr_b16 v[46:47], v8 offset:43264
    ds_read_b64_tr_b16 v[48:49], v8 offset:44032
    v_mfma_f32_32x32x16_bf16 v[68:83], v[20:23], v[16:19], v[68:83]
    ds_read_b64_tr_b16 v[50:51], v8 offset:44288
    ds_read_b128 v[36:39], v7 offset:4096
    v_mfma_f32_32x32x16_bf16 v[100:115], v[24:27], v[16:19], v[100:115]
    s_add_u32 s29, s29, 1
    s_cmp_eq_u32 s29, 3
    s_cselect_b32 s29, 0, s29
    s_mov_b32 s31, 45056
    s_cselect_b32 s31, 0xfffea000, s31
    s_add_u32 s35, s35, 1
    s_cmp_eq_u32 s35, 8
    v_mfma_f32_32x32x16_bf16 v[132:147], v[16:19], v[28:31], v[132:147]
    s_waitcnt lgkmcnt(0)
    v_mfma_f32_32x32x16_bf16 v[52:67], v[40:43], v[32:35], v[52:67]
    v_add_u32 v4, s31, v4
    v_add_u32 v5, s31, v5
    v_add_u32 v6, s31, v6
    v_add_u32 v7, s31, v7
    v_add_u32 v8, s31, v8
    v_mfma_f32_32x32x16_bf16 v[84:99], v[44:47], v[32:35], v[84:99]
    s_cbranch_scc1 .L_p1c_tail
    s_barrier
    ds_read_b128 v[12:15], v4 offset:0
    ds_read_b64_tr_b16 v[20:21], v8 offset:32768
    ds_read_b64_tr_b16 v[22:23], v8 offset:33024
    v_mfma_f32_32x32x16_bf16 v[116:131], v[32:35], v[48:51], v[116:131]
    ds_read_b64_tr_b16 v[24:25], v8 offset:33792
    ds_read_b64_tr_b16 v[26:27], v8 offset:34048
    ds_read_b64_tr_b16 v[28:29], v8 offset:34816
    v_mfma_f32_32x32x16_bf16 v[68:83], v[40:43], v[36:39], v[68:83]
    ds_read_b64_tr_b16 v[30:31], v8 offset:35072
    ds_read_b128 v[16:19], v4 offset:4096
    v_mfma_f32_32x32x16_bf16 v[100:115], v[44:47], v[36:39], v[100:115]
    v_mfma_f32_32x32x16_bf16 v[132:147], v[36:39], v[48:51], v[132:147]
    s_branch .L_p1c_loop
.L_p1c_tail:
    v_mfma_f32_32x32x16_bf16 v[116:131], v[32:35], v[48:51], v[116:131]
    v_mfma_f32_32x32x16_bf16 v[100:115], v[44:47], v[36:39], v[100:115]
    v_mfma_f32_32x32x16_bf16 v[132:147], v[36:39], v[48:51], v[132:147]
    v_mfma_f32_32x32x16_bf16 v[68:83], v[40:43], v[36:39], v[68:83]
    s_nop 3
    s_nop 3
    v_cvt_pk_bf16_f32 v12, v84, v85
    v_cvt_pk_bf16_f32 v13, v86, v87
    v_cvt_pk_bf16_f32 v14, v88, v89
    v_cvt_pk_bf16_f32 v15, v90, v91
    buffer_store_dwordx4 v[12:15], v148, s[12:15], s56 offen offset:0 sc1
    ds_write_b128 v149, v[12:15] offset:0
    v_cvt_pk_bf16_f32 v16, v92, v93
    v_cvt_pk_bf16_f32 v17, v94, v95
    v_cvt_pk_bf16_f32 v18, v96, v97
    v_cvt_pk_bf16_f32 v19, v98, v99
    buffer_store_dwordx4 v[16:19], v148, s[12:15], s57 offen offset:0 sc1
    ds_write_b128 v149, v[16:19] offset:8192
    v_cvt_pk_bf16_f32 v20, v116, v117
    v_cvt_pk_bf16_f32 v21, v118, v119
    v_cvt_pk_bf16_f32 v22, v120, v121
    v_cvt_pk_bf16_f32 v23, v122, v123
    buffer_store_dwordx4 v[20:23], v150, s[12:15], s58 offen offset:0 sc1
    ds_write_b128 v151, v[20:23] offset:0
    v_cvt_pk_bf16_f32 v24, v124, v125
    v_cvt_pk_bf16_f32 v25, v126, v127
    v_cvt_pk_bf16_f32 v26, v128, v129
    v_cvt_pk_bf16_f32 v27, v130, v131
    buffer_store_dwordx4 v[24:27], v150, s[12:15], s58 offen offset:512 sc1
    ds_write_b128 v151, v[24:27] offset:512
    v_cvt_pk_bf16_f32 v28, v100, v101
    v_cvt_pk_bf16_f32 v29, v102, v103
    v_cvt_pk_bf16_f32 v30, v104, v105
    v_cvt_pk_bf16_f32 v31, v106, v107
    buffer_store_dwordx4 v[28:31], v148, s[12:15], s56 offen offset:1024 sc1
    ds_write_b128 v149, v[28:31] offset:1024
    v_cvt_pk_bf16_f32 v32, v108, v109
    v_cvt_pk_bf16_f32 v33, v110, v111
    v_cvt_pk_bf16_f32 v34, v112, v113
    v_cvt_pk_bf16_f32 v35, v114, v115
    buffer_store_dwordx4 v[32:35], v148, s[12:15], s57 offen offset:1024 sc1
    ds_write_b128 v149, v[32:35] offset:9216
    v_cvt_pk_bf16_f32 v36, v132, v133
    v_cvt_pk_bf16_f32 v37, v134, v135
    v_cvt_pk_bf16_f32 v38, v136, v137
    v_cvt_pk_bf16_f32 v39, v138, v139
    buffer_store_dwordx4 v[36:39], v150, s[12:15], s58 offen offset:1024 sc1
    ds_write_b128 v151, v[36:39] offset:1024
    v_cvt_pk_bf16_f32 v40, v140, v141
    v_cvt_pk_bf16_f32 v41, v142, v143
    v_cvt_pk_bf16_f32 v42, v144, v145
    v_cvt_pk_bf16_f32 v43, v146, v147
    buffer_store_dwordx4 v[40:43], v150, s[12:15], s58 offen offset:1536 sc1
    ds_write_b128 v151, v[40:43] offset:1536
    v_pk_mul_f32 v[52:53], v[52:53], s[60:61]
    v_pk_mul_f32 v[54:55], v[54:55], s[60:61]
    v_pk_mul_f32 v[56:57], v[56:57], s[60:61]
    v_pk_mul_f32 v[58:59], v[58:59], s[60:61]
    v_pk_mul_f32 v[60:61], v[60:61], s[60:61]
    v_pk_mul_f32 v[62:63], v[62:63], s[60:61]
    v_pk_mul_f32 v[64:65], v[64:65], s[60:61]
    v_pk_mul_f32 v[66:67], v[66:67], s[60:61]
    v_cvt_pk_bf16_f32 v44, v60, v61
    v_cvt_pk_bf16_f32 v45, v62, v63
    v_cvt_pk_bf16_f32 v46, v64, v65
    v_cvt_pk_bf16_f32 v47, v66, v67
    ds_write_b128 v10, v[44:47] offset:0
    v_cvt_pk_bf16_f32 v152, v52, v53
    v_cvt_pk_bf16_f32 v153, v54, v55
    v_cvt_pk_bf16_f32 v154, v56, v57
    v_cvt_pk_bf16_f32 v155, v58, v59
    v_pk_mul_f32 v[68:69], v[68:69], s[60:61]
    v_pk_mul_f32 v[70:71], v[70:71], s[60:61]
    v_pk_mul_f32 v[72:73], v[72:73], s[60:61]
    v_pk_mul_f32 v[74:75], v[74:75], s[60:61]
    v_pk_mul_f32 v[76:77], v[76:77], s[60:61]
    v_pk_mul_f32 v[78:79], v[78:79], s[60:61]
    v_pk_mul_f32 v[80:81], v[80:81], s[60:61]
    v_pk_mul_f32 v[82:83], v[82:83], s[60:61]
    v_cvt_pk_bf16_f32 v48, v76, v77
    v_cvt_pk_bf16_f32 v49, v78, v79
    v_cvt_pk_bf16_f32 v50, v80, v81
    v_cvt_pk_bf16_f32 v51, v82, v83
    ds_write_b128 v10, v[48:51] offset:1024
    v_cvt_pk_bf16_f32 v156, v68, v69
    v_cvt_pk_bf16_f32 v157, v70, v71
    v_cvt_pk_bf16_f32 v158, v72, v73
    v_cvt_pk_bf16_f32 v159, v74, v75
    s_waitcnt lgkmcnt(0)
    s_setprio 3
    s_barrier
.L_setup:
    s_lshr_b32 s28, s27, 2
    s_and_b32 s29, s27, 3
    v_lshlrev_b32 v3, 4, v2
    s_lshl_b32 s20, s28, 13
    v_add_u32 v4, s20, v3
    v_and_b32 v72, 15, v2
    v_lshlrev_b32 v72, 4, v72
    v_lshrrev_b32 v1, 5, v2
    v_lshl_add_u32 v72, v1, 8, v72
    s_mul_i32 s20, s28, 8192
    s_add_u32 s20, s20, 16384
    v_add_u32 v5, s20, v72
    v_mov_b32 v7, 0xdddddddd
    v_mov_b32 v1, 143360
    s_lshl_b32 s20, s29, 11
    v_add_u32 v72, s20, v3
    v_add_u32 v72, 135168, v72
    s_lshl_b32 s54, s26, 1
    s_add_u32 s54, s54, s28
    s_lshl_b32 s23, s24, 3
    s_lshl_b32 s21, s29, 1
    s_add_u32 s23, s23, s21
    s_lshl_b32 s55, s22, 6
    s_add_u32 s55, s55, s23
    s_lshl_b32 s55, s55, 5
    s_and_b32 s21, s54, 31
    s_add_u32 s55, s55, s21
    s_lshl_b32 s55, s55, 10
    s_add_u32 s55, s55, 8388608
    s_add_u32 s59, s55, 32768
    s_lshl_b32 s63, s26, 3
    s_add_u32 s63, s63, s24
    s_lshl_b32 s63, s63, 7
    s_lshl_b32 s21, s27, 3
    s_add_u32 s63, s63, s21
    s_add_u32 s63, s63, 12582912
    s_and_b32 s38, s25, 1
    s_lshl_b32 s38, s38, 2
    s_add_u32 s38, s38, s29
    s_xor_b32 s38, s38, s28
    s_lshl_b32 s21, s24, 3
    s_add_u32 s38, s38, s21
    s_lshl_b32 s34, s22, 6
    s_add_u32 s34, s34, s38
    s_lshl_b32 s34, s34, 1
    s_add_u32 s34, s34, s28
    s_lshl_b32 s34, s34, 14
    s_add_u32 s34, s34, 8388608
    s_mov_b32 s37, 0
    s_mov_b32 s4, 0
    s_mov_b32 s5, 4096
    s_mov_b32 s6, 8192
    s_mov_b32 s7, 12288
    s_mov_b32 s41, 0
    s_mov_b32 s40, 0
    s_mov_b32 s43, 0x76800000
    v_mov_b32 v28, 0
    v_mov_b32 v29, 0
    v_mov_b32 v30, 0
    v_mov_b32 v31, 0
    s_nop 1
    v_mfma_f32_32x32x16_bf16 v[112:127], v[28:31], v[28:31], 0
    v_mfma_f32_32x32x16_bf16 v[128:143], v[28:31], v[28:31], 0
    v_mfma_f32_32x32x16_bf16 v[48:63], v[28:31], v[28:31], 0
    v_and_b32 v74, 27, v2
    v_cmp_eq_u32 vcc, 16, v74
    v_mov_b32 v75, 0x3f803f80
    s_mov_b32 s10, 0x0000ffff
    s_mov_b32 s11, 0x0000ffff
    v_cndmask_b32 v16, 0, v75, vcc
    v_cndmask_b32 v17, 0, v75, vcc
    v_pk_mov_b32 v[18:19], v[16:17], v[16:17] op_sel:[0,1]
    v_pk_mov_b32 v[20:21], v[16:17], v[16:17] op_sel:[0,1]
    v_pk_mov_b32 v[22:23], v[16:17], v[16:17] op_sel:[0,1]
    v_pk_mov_b32 v[24:25], v[16:17], v[16:17] op_sel:[0,1]
    v_pk_mov_b32 v[26:27], v[16:17], v[16:17] op_sel:[0,1]
    v_pk_mov_b32 v[28:29], v[16:17], v[16:17] op_sel:[0,1]
    v_pk_mov_b32 v[30:31], v[16:17], v[16:17] op_sel:[0,1]
    s_cmp_lt_u32 s27, 4
    s_cbranch_scc1 .L_p2
    s_barrier
    ds_read_b128 v[152:155], v72
    ds_read_b128 v[156:159], v72 offset:1024
.L_p2:
    ds_read_b128 v[8:11], v4
    ds_read_b64 v[144:145], v1
    ds_read_b128 v[12:15], v4 offset:1024
    s_mov_b64 exec, s[10:11]
    ds_read_b128 v[16:19], v5
    ds_read_b128 v[24:27], v5 offset:512
    s_mov_b64 exec, -1
    v_mov_b32 v1, 0
    s_waitcnt lgkmcnt(4)
    v_mfma_f32_32x32x16_bf16 v[80:95], v[8:11], v[152:155], 0
    v_mfma_f32_32x32x16_bf16 v[96:111], v[8:11], v[156:159], 0
    s_waitcnt lgkmcnt(3)
    v_readfirstlane_b32 s52, v144
    v_readfirstlane_b32 s53, v145
    s_nop 7
    v_max3_f32 v64, v80, v81, v82
    v_max3_f32 v64, v64, v83, v84
    v_max3_f32 v64, v64, v85, v86
    v_max3_f32 v64, v64, v87, v88
    v_max3_f32 v64, v64, v89, v90
    v_max3_f32 v64, v64, v91, v92
    v_max3_f32 v64, v64, v93, v94
    v_max_f32 v64, v64, v95
    v_mov_b32 v66, v64
    s_nop 1
    v_permlane32_swap_b32 v64, v66
    s_nop 1
    v_min_f32 v80, -v64, -v66
    v_min_f32 v81, -v64, -v66
    v_pk_mov_b32 v[82:83], v[80:81], v[80:81] op_sel:[0,1]
    v_pk_mov_b32 v[84:85], v[80:81], v[80:81] op_sel:[0,1]
    v_pk_mov_b32 v[86:87], v[80:81], v[80:81] op_sel:[0,1]
    v_pk_mov_b32 v[88:89], v[80:81], v[80:81] op_sel:[0,1]
    v_pk_mov_b32 v[90:91], v[80:81], v[80:81] op_sel:[0,1]
    v_pk_mov_b32 v[92:93], v[80:81], v[80:81] op_sel:[0,1]
    v_pk_mov_b32 v[94:95], v[80:81], v[80:81] op_sel:[0,1]
    s_nop 1
    v_mfma_f32_32x32x16_bf16 v[32:47], v[8:11], v[152:155], v[80:95]
    v_max3_f32 v65, v96, v97, v98
    v_max3_f32 v65, v65, v99, v100
    v_max3_f32 v65, v65, v101, v102
    v_max3_f32 v65, v65, v103, v104
    v_max3_f32 v65, v65, v105, v106
    v_max3_f32 v65, v65, v107, v108
    v_max3_f32 v65, v65, v109, v110
    v_max_f32 v65, v65, v111
    v_mov_b32 v67, v65
    s_nop 1
    v_permlane32_swap_b32 v65, v67
    s_nop 1
    v_min_f32 v96, -v65, -v67
    v_min_f32 v97, -v65, -v67
    v_pk_mov_b32 v[98:99], v[96:97], v[96:97] op_sel:[0,1]
    v_pk_mov_b32 v[100:101], v[96:97], v[96:97] op_sel:[0,1]
    v_pk_mov_b32 v[102:103], v[96:97], v[96:97] op_sel:[0,1]
    v_pk_mov_b32 v[104:105], v[96:97], v[96:97] op_sel:[0,1]
    v_pk_mov_b32 v[106:107], v[96:97], v[96:97] op_sel:[0,1]
    v_pk_mov_b32 v[108:109], v[96:97], v[96:97] op_sel:[0,1]
    v_pk_mov_b32 v[110:111], v[96:97], v[96:97] op_sel:[0,1]
    s_cmp_lt_u32 s27, 4
    s_cbranch_scc0 .L_nopub
    s_waitcnt vmcnt(0)
    s_mov_b64 exec, 1
    buffer_store_dwordx2 v[144:145], v1, s[12:15], s63 offen sc1
    s_mov_b64 exec, -1
.L_nopub:
    s_setprio 2
.p2align 6
.L_p2_loop:
    s_waitcnt lgkmcnt(0)
    v_exp_f32 v32, v32
    v_exp_f32 v33, v33
    v_smfmac_f32_32x32x32_bf16 v[128:143], v[28:31], v[56:63], v7
    v_exp_f32 v34, v34
    v_exp_f32 v35, v35
    v_exp_f32 v36, v36
    v_mfma_f32_32x32x16_bf16 v[48:63], v[8:11], v[156:159], v[96:111]
    v_exp_f32 v37, v37
    v_exp_f32 v38, v38
    v_exp_f32 v39, v39
    v_exp_f32 v40, v40
    v_exp_f32 v41, v41
    v_smfmac_f32_32x32x32_bf16 v[112:127], v[16:19], v[32:39], v7
    v_exp_f32 v42, v42
    s_mov_b64 exec, s[10:11]
    ds_read_b128 v[20:23], v5 offset:1024
    ds_read_b128 v[28:31], v5 offset:1536
    s_mov_b64 exec, -1
    v_exp_f32 v43, v43
    v_exp_f32 v44, v44
    v_exp_f32 v45, v45
    ds_read_b128 v[8:11], v4 offset:2048
    v_exp_f32 v46, v46
    v_exp_f32 v47, v47
    v_exp_f32 v48, v48
    v_exp_f32 v49, v49
    v_smfmac_f32_32x32x32_bf16 v[112:127], v[24:27], v[40:47], v7
    v_exp_f32 v50, v50
    v_exp_f32 v51, v51
    v_exp_f32 v52, v52
    v_mfma_f32_32x32x16_bf16 v[32:47], v[12:15], v[152:155], v[80:95]
    v_exp_f32 v53, v53
    v_exp_f32 v54, v54
    v_exp_f32 v55, v55
    v_exp_f32 v56, v56
    v_exp_f32 v57, v57
    v_smfmac_f32_32x32x32_bf16 v[128:143], v[16:19], v[48:55], v7
    v_exp_f32 v58, v58
    v_exp_f32 v59, v59
    v_exp_f32 v60, v60
    v_exp_f32 v61, v61
    v_exp_f32 v62, v62
    v_exp_f32 v63, v63
    s_waitcnt lgkmcnt(0)
    v_exp_f32 v32, v32
    v_exp_f32 v33, v33
    v_smfmac_f32_32x32x32_bf16 v[128:143], v[24:27], v[56:63], v7
    v_exp_f32 v34, v34
    v_exp_f32 v35, v35
    v_exp_f32 v36, v36
    v_mfma_f32_32x32x16_bf16 v[48:63], v[12:15], v[156:159], v[96:111]
    v_exp_f32 v37, v37
    v_exp_f32 v38, v38
    v_exp_f32 v39, v39
    v_exp_f32 v40, v40
    v_exp_f32 v41, v41
    v_smfmac_f32_32x32x32_bf16 v[112:127], v[20:23], v[32:39], v7
    v_exp_f32 v42, v42
    s_mov_b64 exec, s[10:11]
    ds_read_b128 v[16:19], v5 offset:2048
    ds_read_b128 v[24:27], v5 offset:2560
    s_mov_b64 exec, -1
    v_exp_f32 v43, v43
    v_exp_f32 v44, v44
    v_exp_f32 v45, v45
    ds_read_b128 v[12:15], v4 offset:3072
    v_exp_f32 v46, v46
    v_exp_f32 v47, v47
    v_exp_f32 v48, v48
    v_exp_f32 v49, v49
    v_smfmac_f32_32x32x32_bf16 v[112:127], v[28:31], v[40:47], v7
    v_exp_f32 v50, v50
    v_exp_f32 v51, v51
    v_exp_f32 v52, v52
    v_mfma_f32_32x32x16_bf16 v[32:47], v[8:11], v[152:155], v[80:95]
    v_exp_f32 v53, v53
    v_exp_f32 v54, v54
    v_exp_f32 v55, v55
    v_exp_f32 v56, v56
    v_exp_f32 v57, v57
    v_smfmac_f32_32x32x32_bf16 v[128:143], v[20:23], v[48:55], v7
    v_exp_f32 v58, v58
    v_exp_f32 v59, v59
    v_exp_f32 v60, v60
    v_exp_f32 v61, v61
    v_exp_f32 v62, v62
    v_exp_f32 v63, v63
    s_waitcnt lgkmcnt(0)
    v_exp_f32 v32, v32
    v_exp_f32 v33, v33
    v_smfmac_f32_32x32x32_bf16 v[128:143], v[28:31], v[56:63], v7
    v_exp_f32 v34, v34
    v_exp_f32 v35, v35
    v_exp_f32 v36, v36
    v_mfma_f32_32x32x16_bf16 v[48:63], v[8:11], v[156:159], v[96:111]
    v_exp_f32 v37, v37
    v_exp_f32 v38, v38
    v_exp_f32 v39, v39
    v_exp_f32 v40, v40
    v_exp_f32 v41, v41
    v_smfmac_f32_32x32x32_bf16 v[112:127], v[16:19], v[32:39], v7
    v_exp_f32 v42, v42
    s_mov_b64 exec, s[10:11]
    ds_read_b128 v[20:23], v5 offset:3072
    ds_read_b128 v[28:31], v5 offset:3584
    s_mov_b64 exec, -1
    v_exp_f32 v43, v43
    v_exp_f32 v44, v44
    v_exp_f32 v45, v45
    ds_read_b128 v[8:11], v4 offset:4096
    v_exp_f32 v46, v46
    v_exp_f32 v47, v47
    v_exp_f32 v48, v48
    v_exp_f32 v49, v49
    v_smfmac_f32_32x32x32_bf16 v[112:127], v[24:27], v[40:47], v7
    v_exp_f32 v50, v50
    v_exp_f32 v51, v51
    v_exp_f32 v52, v52
    v_mfma_f32_32x32x16_bf16 v[32:47], v[12:15], v[152:155], v[80:95]
    v_exp_f32 v53, v53
    v_exp_f32 v54, v54
    v_exp_f32 v55, v55
    v_exp_f32 v56, v56
    v_exp_f32 v57, v57
    v_smfmac_f32_32x32x32_bf16 v[128:143], v[16:19], v[48:55], v7
    v_exp_f32 v58, v58
    v_exp_f32 v59, v59
    v_exp_f32 v60, v60
    v_exp_f32 v61, v61
    v_exp_f32 v62, v62
    v_exp_f32 v63, v63
    s_waitcnt lgkmcnt(0)
    v_exp_f32 v32, v32
    v_exp_f32 v33, v33
    v_smfmac_f32_32x32x32_bf16 v[128:143], v[24:27], v[56:63], v7
    v_exp_f32 v34, v34
    v_exp_f32 v35, v35
    v_exp_f32 v36, v36
    v_mfma_f32_32x32x16_bf16 v[48:63], v[12:15], v[156:159], v[96:111]
    v_exp_f32 v37, v37
    v_exp_f32 v38, v38
    v_exp_f32 v39, v39
    v_exp_f32 v40, v40
    v_exp_f32 v41, v41
    v_smfmac_f32_32x32x32_bf16 v[112:127], v[20:23], v[32:39], v7
    v_exp_f32 v42, v42
    s_mov_b64 exec, s[10:11]
    ds_read_b128 v[16:19], v5 offset:4096
    ds_read_b128 v[24:27], v5 offset:4608
    s_mov_b64 exec, -1
    v_exp_f32 v43, v43
    v_exp_f32 v44, v44
    v_exp_f32 v45, v45
    ds_read_b128 v[12:15], v4 offset:5120
    v_exp_f32 v46, v46
    v_exp_f32 v47, v47
    s_setprio 1
    v_exp_f32 v48, v48
    v_exp_f32 v49, v49
    v_smfmac_f32_32x32x32_bf16 v[112:127], v[28:31], v[40:47], v7
    v_exp_f32 v50, v50
    v_exp_f32 v51, v51
    v_exp_f32 v52, v52
    v_mfma_f32_32x32x16_bf16 v[32:47], v[8:11], v[152:155], v[80:95]
    v_exp_f32 v53, v53
    v_exp_f32 v54, v54
    v_exp_f32 v55, v55
    v_exp_f32 v56, v56
    v_exp_f32 v57, v57
    v_smfmac_f32_32x32x32_bf16 v[128:143], v[20:23], v[48:55], v7
    v_exp_f32 v58, v58
    v_exp_f32 v59, v59
    v_exp_f32 v60, v60
    v_exp_f32 v61, v61
    v_exp_f32 v62, v62
    v_exp_f32 v63, v63
    s_waitcnt lgkmcnt(0)
    v_exp_f32 v32, v32
    v_exp_f32 v33, v33
    v_smfmac_f32_32x32x32_bf16 v[128:143], v[28:31], v[56:63], v7
    v_exp_f32 v34, v34
    v_exp_f32 v35, v35
    v_exp_f32 v36, v36
    v_mfma_f32_32x32x16_bf16 v[48:63], v[8:11], v[156:159], v[96:111]
    v_exp_f32 v37, v37
    v_exp_f32 v38, v38
    v_exp_f32 v39, v39
    v_exp_f32 v40, v40
    v_exp_f32 v41, v41
    v_smfmac_f32_32x32x32_bf16 v[112:127], v[16:19], v[32:39], v7
    v_exp_f32 v42, v42
    s_mov_b64 exec, s[10:11]
    ds_read_b128 v[20:23], v5 offset:5120
    ds_read_b128 v[28:31], v5 offset:5632
    s_mov_b64 exec, -1
    v_exp_f32 v43, v43
    v_exp_f32 v44, v44
    v_exp_f32 v45, v45
    ds_read_b128 v[8:11], v4 offset:6144
    v_exp_f32 v46, v46
    v_exp_f32 v47, v47
    s_add_u32 s40, s40, 1
    s_cmp_eq_u32 s40, 3
    s_cselect_b32 s40, 0, s40
    s_mov_b32 s42, 32768
    s_cselect_b32 s42, 0xffff0000, s42
    v_exp_f32 v48, v48
    v_exp_f32 v49, v49
    v_smfmac_f32_32x32x32_bf16 v[112:127], v[24:27], v[40:47], v7
    v_exp_f32 v50, v50
    v_exp_f32 v51, v51
    v_exp_f32 v52, v52
    v_mfma_f32_32x32x16_bf16 v[32:47], v[12:15], v[152:155], v[80:95]
    v_exp_f32 v53, v53
    v_exp_f32 v54, v54
    v_exp_f32 v55, v55
    v_exp_f32 v56, v56
    v_exp_f32 v57, v57
    v_smfmac_f32_32x32x32_bf16 v[128:143], v[16:19], v[48:55], v7
    v_exp_f32 v58, v58
    v_exp_f32 v59, v59
    v_exp_f32 v60, v60
    v_exp_f32 v61, v61
    v_exp_f32 v62, v62
    v_exp_f32 v63, v63
    s_waitcnt lgkmcnt(0)
    v_exp_f32 v32, v32
    v_exp_f32 v33, v33
    v_smfmac_f32_32x32x32_bf16 v[128:143], v[24:27], v[56:63], v7
    v_exp_f32 v34, v34
    v_exp_f32 v35, v35
    v_exp_f32 v36, v36
    v_mfma_f32_32x32x16_bf16 v[48:63], v[12:15], v[156:159], v[96:111]
    v_exp_f32 v37, v37
    v_exp_f32 v38, v38
    v_exp_f32 v39, v39
    v_exp_f32 v40, v40
    v_exp_f32 v41, v41
    v_smfmac_f32_32x32x32_bf16 v[112:127], v[20:23], v[32:39], v7
    v_exp_f32 v42, v42
    s_mov_b64 exec, s[10:11]
    ds_read_b128 v[16:19], v5 offset:6144
    ds_read_b128 v[24:27], v5 offset:6656
    s_mov_b64 exec, -1
    v_exp_f32 v43, v43
    v_exp_f32 v44, v44
    v_exp_f32 v45, v45
    ds_read_b128 v[12:15], v4 offset:7168
    v_exp_f32 v46, v46
    v_exp_f32 v47, v47
    v_exp_f32 v48, v48
    v_exp_f32 v49, v49
    v_smfmac_f32_32x32x32_bf16 v[112:127], v[28:31], v[40:47], v7
    v_exp_f32 v50, v50
    v_exp_f32 v51, v51
    v_exp_f32 v52, v52
    v_mfma_f32_32x32x16_bf16 v[32:47], v[8:11], v[152:155], v[80:95]
    v_exp_f32 v53, v53
    v_exp_f32 v54, v54
    v_exp_f32 v55, v55
    v_exp_f32 v56, v56
    v_exp_f32 v57, v57
    v_smfmac_f32_32x32x32_bf16 v[128:143], v[20:23], v[48:55], v7
    v_exp_f32 v58, v58
    v_exp_f32 v59, v59
    v_exp_f32 v60, v60
    v_exp_f32 v61, v61
    v_exp_f32 v62, v62
    v_exp_f32 v63, v63
    s_waitcnt lgkmcnt(0)
    v_exp_f32 v32, v32
    v_exp_f32 v33, v33
    v_smfmac_f32_32x32x32_bf16 v[128:143], v[28:31], v[56:63], v7
    v_exp_f32 v34, v34
    v_exp_f32 v35, v35
    v_exp_f32 v36, v36
    v_mfma_f32_32x32x16_bf16 v[48:63], v[8:11], v[156:159], v[96:111]
    v_exp_f32 v37, v37
    v_exp_f32 v38, v38
    v_exp_f32 v39, v39
    v_exp_f32 v40, v40
    v_exp_f32 v41, v41
    v_smfmac_f32_32x32x32_bf16 v[112:127], v[16:19], v[32:39], v7
    v_exp_f32 v42, v42
    s_mov_b64 exec, s[10:11]
    ds_read_b128 v[20:23], v5 offset:7168
    ds_read_b128 v[28:31], v5 offset:7680
    s_mov_b64 exec, -1
    v_exp_f32 v43, v43
    v_exp_f32 v44, v44
    v_exp_f32 v45, v45
    v_exp_f32 v46, v46
    v_exp_f32 v47, v47
    s_setprio 0
    v_exp_f32 v48, v48
    v_exp_f32 v49, v49
    v_smfmac_f32_32x32x32_bf16 v[112:127], v[24:27], v[40:47], v7
    v_exp_f32 v50, v50
    v_exp_f32 v51, v51
    v_exp_f32 v52, v52
    v_mfma_f32_32x32x16_bf16 v[32:47], v[12:15], v[152:155], v[80:95]
    v_exp_f32 v53, v53
    v_exp_f32 v54, v54
    v_exp_f32 v55, v55
    v_exp_f32 v56, v56
    v_exp_f32 v57, v57
    v_smfmac_f32_32x32x32_bf16 v[128:143], v[16:19], v[48:55], v7
    v_exp_f32 v58, v58
    v_exp_f32 v59, v59
    v_exp_f32 v60, v60
    v_exp_f32 v61, v61
    v_exp_f32 v62, v62
    v_exp_f32 v63, v63
    s_waitcnt lgkmcnt(0)
    v_add_u32 v4, s42, v4
    s_barrier
    s_setprio 2
    ds_read_b128 v[8:11], v4 offset:0
    v_exp_f32 v32, v32
    v_exp_f32 v33, v33
    v_smfmac_f32_32x32x32_bf16 v[128:143], v[24:27], v[56:63], v7
    v_exp_f32 v34, v34
    v_exp_f32 v35, v35
    v_exp_f32 v36, v36
    v_mfma_f32_32x32x16_bf16 v[48:63], v[12:15], v[156:159], v[96:111]
    v_exp_f32 v37, v37
    v_exp_f32 v38, v38
    v_exp_f32 v39, v39
    v_exp_f32 v40, v40
    v_exp_f32 v41, v41
    v_smfmac_f32_32x32x32_bf16 v[112:127], v[20:23], v[32:39], v7
    v_add_u32 v5, s42, v5
    v_exp_f32 v42, v42
    s_mov_b64 exec, s[10:11]
    ds_read_b128 v[16:19], v5 offset:0
    ds_read_b128 v[24:27], v5 offset:512
    s_mov_b64 exec, -1
    v_exp_f32 v43, v43
    v_exp_f32 v44, v44
    v_exp_f32 v45, v45
    ds_read_b128 v[12:15], v4 offset:1024
    v_exp_f32 v46, v46
    v_exp_f32 v47, v47
    v_exp_f32 v48, v48
    v_exp_f32 v49, v49
    v_smfmac_f32_32x32x32_bf16 v[112:127], v[28:31], v[40:47], v7
    v_exp_f32 v50, v50
    v_exp_f32 v51, v51
    v_exp_f32 v52, v52
    s_waitcnt lgkmcnt(3)
    v_mfma_f32_32x32x16_bf16 v[32:47], v[8:11], v[152:155], v[80:95]
    v_exp_f32 v53, v53
    v_exp_f32 v54, v54
    v_exp_f32 v55, v55
    v_exp_f32 v56, v56
    v_exp_f32 v57, v57
    v_smfmac_f32_32x32x32_bf16 v[128:143], v[20:23], v[48:55], v7
    s_add_u32 s41, s41, 1
    s_cmp_lt_u32 s41, 7
    v_exp_f32 v58, v58
    v_exp_f32 v59, v59
    v_exp_f32 v60, v60
    v_exp_f32 v61, v61
    v_exp_f32 v62, v62
    v_exp_f32 v63, v63
    s_cbranch_scc1 .L_p2_loop
    s_setprio 3
    s_waitcnt lgkmcnt(0)
    v_exp_f32 v32, v32
    ds_read_b128 v[8:11], v4 offset:2048
    v_exp_f32 v33, v33
    v_smfmac_f32_32x32x32_bf16 v[128:143], v[28:31], v[56:63], v7
    s_mov_b64 exec, s[10:11]
    ds_read_b128 v[20:23], v5 offset:1024
    ds_read_b128 v[28:31], v5 offset:1536
    s_mov_b64 exec, -1
    v_exp_f32 v34, v34
    v_exp_f32 v35, v35
    v_exp_f32 v36, v36
    v_mfma_f32_32x32x16_bf16 v[48:63], v[12:15], v[152:155], v[80:95]
    v_exp_f32 v37, v37
    v_exp_f32 v38, v38
    v_exp_f32 v39, v39
    v_exp_f32 v40, v40
    v_exp_f32 v41, v41
    v_smfmac_f32_32x32x32_bf16 v[112:127], v[16:19], v[32:39], v7
    v_exp_f32 v42, v42
    v_exp_f32 v43, v43
    v_exp_f32 v44, v44
    v_exp_f32 v45, v45
    v_exp_f32 v46, v46
    v_exp_f32 v47, v47
    s_waitcnt lgkmcnt(0)
    v_exp_f32 v48, v48
    ds_read_b128 v[12:15], v4 offset:3072
    v_exp_f32 v49, v49
    v_smfmac_f32_32x32x32_bf16 v[112:127], v[24:27], v[40:47], v7
    s_mov_b64 exec, s[10:11]
    ds_read_b128 v[16:19], v5 offset:2048
    ds_read_b128 v[24:27], v5 offset:2560
    s_mov_b64 exec, -1
    v_exp_f32 v50, v50
    v_exp_f32 v51, v51
    v_exp_f32 v52, v52
    v_mfma_f32_32x32x16_bf16 v[32:47], v[8:11], v[152:155], v[80:95]
    v_exp_f32 v53, v53
    v_exp_f32 v54, v54
    v_exp_f32 v55, v55
    v_exp_f32 v56, v56
    v_exp_f32 v57, v57
    v_smfmac_f32_32x32x32_bf16 v[112:127], v[20:23], v[48:55], v7
    v_exp_f32 v58, v58
    v_exp_f32 v59, v59
    v_exp_f32 v60, v60
    v_exp_f32 v61, v61
    v_exp_f32 v62, v62
    v_exp_f32 v63, v63
    s_waitcnt lgkmcnt(0)
    v_exp_f32 v32, v32
    ds_read_b128 v[8:11], v4 offset:4096
    v_exp_f32 v33, v33
    v_smfmac_f32_32x32x32_bf16 v[112:127], v[28:31], v[56:63], v7
    s_mov_b64 exec, s[10:11]
    ds_read_b128 v[20:23], v5 offset:3072
    ds_read_b128 v[28:31], v5 offset:3584
    s_mov_b64 exec, -1
    v_exp_f32 v34, v34
    v_exp_f32 v35, v35
    v_exp_f32 v36, v36
    v_mfma_f32_32x32x16_bf16 v[48:63], v[12:15], v[152:155], v[80:95]
    v_exp_f32 v37, v37
    v_exp_f32 v38, v38
    v_exp_f32 v39, v39
    v_exp_f32 v40, v40
    v_exp_f32 v41, v41
    v_smfmac_f32_32x32x32_bf16 v[112:127], v[16:19], v[32:39], v7
    v_exp_f32 v42, v42
    v_exp_f32 v43, v43
    v_exp_f32 v44, v44
    v_exp_f32 v45, v45
    v_exp_f32 v46, v46
    v_exp_f32 v47, v47
    s_waitcnt lgkmcnt(0)
    v_exp_f32 v48, v48
    ds_read_b128 v[12:15], v4 offset:5120
    v_exp_f32 v49, v49
    v_smfmac_f32_32x32x32_bf16 v[112:127], v[24:27], v[40:47], v7
    s_mov_b64 exec, s[10:11]
    ds_read_b128 v[16:19], v5 offset:4096
    ds_read_b128 v[24:27], v5 offset:4608
    s_mov_b64 exec, -1
    v_exp_f32 v50, v50
    v_exp_f32 v51, v51
    v_exp_f32 v52, v52
    v_mfma_f32_32x32x16_bf16 v[32:47], v[8:11], v[152:155], v[80:95]
    v_exp_f32 v53, v53
    v_exp_f32 v54, v54
    v_exp_f32 v55, v55
    v_exp_f32 v56, v56
    v_exp_f32 v57, v57
    v_smfmac_f32_32x32x32_bf16 v[112:127], v[20:23], v[48:55], v7
    v_exp_f32 v58, v58
    v_exp_f32 v59, v59
    v_exp_f32 v60, v60
    v_exp_f32 v61, v61
    v_exp_f32 v62, v62
    v_exp_f32 v63, v63
    s_waitcnt lgkmcnt(0)
    v_exp_f32 v32, v32
    ds_read_b128 v[8:11], v4 offset:6144
    v_exp_f32 v33, v33
    v_smfmac_f32_32x32x32_bf16 v[112:127], v[28:31], v[56:63], v7
    s_mov_b64 exec, s[10:11]
    ds_read_b128 v[20:23], v5 offset:5120
    ds_read_b128 v[28:31], v5 offset:5632
    s_mov_b64 exec, -1
    v_exp_f32 v34, v34
    v_exp_f32 v35, v35
    v_exp_f32 v36, v36
    v_mfma_f32_32x32x16_bf16 v[48:63], v[12:15], v[152:155], v[80:95]
    v_exp_f32 v37, v37
    v_exp_f32 v38, v38
    v_exp_f32 v39, v39
    v_exp_f32 v40, v40
    v_exp_f32 v41, v41
    v_smfmac_f32_32x32x32_bf16 v[112:127], v[16:19], v[32:39], v7
    v_exp_f32 v42, v42
    v_exp_f32 v43, v43
    v_exp_f32 v44, v44
    v_exp_f32 v45, v45
    v_exp_f32 v46, v46
    v_exp_f32 v47, v47
    s_waitcnt lgkmcnt(0)
    v_exp_f32 v48, v48
    ds_read_b128 v[12:15], v4 offset:7168
    v_exp_f32 v49, v49
    v_smfmac_f32_32x32x32_bf16 v[112:127], v[24:27], v[40:47], v7
    s_mov_b64 exec, s[10:11]
    ds_read_b128 v[16:19], v5 offset:6144
    ds_read_b128 v[24:27], v5 offset:6656
    s_mov_b64 exec, -1
    v_exp_f32 v50, v50
    v_exp_f32 v51, v51
    v_exp_f32 v52, v52
    v_mfma_f32_32x32x16_bf16 v[32:47], v[8:11], v[152:155], v[80:95]
    v_exp_f32 v53, v53
    v_exp_f32 v54, v54
    v_exp_f32 v55, v55
    v_exp_f32 v56, v56
    v_exp_f32 v57, v57
    v_smfmac_f32_32x32x32_bf16 v[112:127], v[20:23], v[48:55], v7
    v_exp_f32 v58, v58
    v_exp_f32 v59, v59
    v_exp_f32 v60, v60
    v_exp_f32 v61, v61
    v_exp_f32 v62, v62
    v_exp_f32 v63, v63
    s_waitcnt lgkmcnt(0)
    v_exp_f32 v32, v32
    ds_read_b128 v[8:11], v4 offset:0
    v_exp_f32 v33, v33
    v_smfmac_f32_32x32x32_bf16 v[112:127], v[28:31], v[56:63], v7
    s_mov_b64 exec, s[10:11]
    ds_read_b128 v[20:23], v5 offset:7168
    ds_read_b128 v[28:31], v5 offset:7680
    s_mov_b64 exec, -1
    v_exp_f32 v34, v34
    v_exp_f32 v35, v35
    v_exp_f32 v36, v36
    v_mfma_f32_32x32x16_bf16 v[48:63], v[12:15], v[152:155], v[80:95]
    v_exp_f32 v37, v37
    v_exp_f32 v38, v38
    v_exp_f32 v39, v39
    v_exp_f32 v40, v40
    v_exp_f32 v41, v41
    v_smfmac_f32_32x32x32_bf16 v[112:127], v[16:19], v[32:39], v7
    v_exp_f32 v42, v42
    v_exp_f32 v43, v43
    v_exp_f32 v44, v44
    v_exp_f32 v45, v45
    v_exp_f32 v46, v46
    v_exp_f32 v47, v47
    s_waitcnt lgkmcnt(0)
    v_exp_f32 v48, v48
    ds_read_b128 v[12:15], v4 offset:1024
    v_exp_f32 v49, v49
    v_smfmac_f32_32x32x32_bf16 v[112:127], v[24:27], v[40:47], v7
    s_mov_b64 exec, s[10:11]
    ds_read_b128 v[16:19], v5 offset:0
    ds_read_b128 v[24:27], v5 offset:512
    s_mov_b64 exec, -1
    v_exp_f32 v50, v50
    v_exp_f32 v51, v51
    v_exp_f32 v52, v52
    v_mfma_f32_32x32x16_bf16 v[32:47], v[8:11], v[156:159], v[96:111]
    v_exp_f32 v53, v53
    v_exp_f32 v54, v54
    v_exp_f32 v55, v55
    v_exp_f32 v56, v56
    v_exp_f32 v57, v57
    v_smfmac_f32_32x32x32_bf16 v[112:127], v[20:23], v[48:55], v7
    v_exp_f32 v58, v58
    v_exp_f32 v59, v59
    v_exp_f32 v60, v60
    v_exp_f32 v61, v61
    v_exp_f32 v62, v62
    v_exp_f32 v63, v63
    s_waitcnt lgkmcnt(0)
    v_exp_f32 v32, v32
    ds_read_b128 v[8:11], v4 offset:2048
    v_exp_f32 v33, v33
    v_smfmac_f32_32x32x32_bf16 v[112:127], v[28:31], v[56:63], v7
    s_mov_b64 exec, s[10:11]
    ds_read_b128 v[20:23], v5 offset:1024
    ds_read_b128 v[28:31], v5 offset:1536
    s_mov_b64 exec, -1
    v_exp_f32 v34, v34
    v_exp_f32 v35, v35
    v_exp_f32 v36, v36
    v_mfma_f32_32x32x16_bf16 v[48:63], v[12:15], v[156:159], v[96:111]
    v_exp_f32 v37, v37
    v_exp_f32 v38, v38
    v_exp_f32 v39, v39
    v_exp_f32 v40, v40
    v_exp_f32 v41, v41
    v_smfmac_f32_32x32x32_bf16 v[128:143], v[16:19], v[32:39], v7
    v_exp_f32 v42, v42
    v_exp_f32 v43, v43
    v_exp_f32 v44, v44
    v_exp_f32 v45, v45
    v_exp_f32 v46, v46
    v_exp_f32 v47, v47
    v_rcp_f32 v68, v120
    v_fma_f32 v69, 0, v112, v120
    v_fmac_f32 v69, 0, v113
    v_fmac_f32 v69, 0, v114
    v_fmac_f32 v69, 0, v115
    v_fmac_f32 v69, 0, v116
    v_fmac_f32 v69, 0, v117
    v_fmac_f32 v69, 0, v118
    v_fmac_f32 v69, 0, v119
    v_cmp_nlt_f32 s[44:45], v69, s43
    v_mul_f32 v112, v112, v68
    v_mul_f32 v113, v113, v68
    v_mul_f32 v114, v114, v68
    v_mul_f32 v115, v115, v68
    v_mul_f32 v116, v116, v68
    v_mul_f32 v117, v117, v68
    v_mul_f32 v118, v118, v68
    v_mul_f32 v119, v119, v68
    v_cvt_pk_bf16_f32 v148, v112, v113
    v_cvt_pk_bf16_f32 v149, v114, v115
    v_cvt_pk_bf16_f32 v150, v116, v117
    v_cvt_pk_bf16_f32 v151, v118, v119
    v_min_u32 v148, -2, v148
    v_min_u32 v149, -2, v149
    v_min_u32 v150, -2, v150
    v_min_u32 v151, -2, v151
    s_cmp_lg_u64 s[44:45], 0
    s_cbranch_scc1 .L_skipA
    buffer_store_dwordx4 v[148:151], v3, s[12:15], s55 offen sc1
.L_skipA:
    s_waitcnt lgkmcnt(0)
    v_exp_f32 v48, v48
    ds_read_b128 v[12:15], v4 offset:3072
    v_exp_f32 v49, v49
    v_smfmac_f32_32x32x32_bf16 v[128:143], v[24:27], v[40:47], v7
    s_mov_b64 exec, s[10:11]
    ds_read_b128 v[16:19], v5 offset:2048
    ds_read_b128 v[24:27], v5 offset:2560
    s_mov_b64 exec, -1
    v_exp_f32 v50, v50
    v_exp_f32 v51, v51
    v_exp_f32 v52, v52
    v_mfma_f32_32x32x16_bf16 v[32:47], v[8:11], v[156:159], v[96:111]
    v_exp_f32 v53, v53
    v_exp_f32 v54, v54
    v_exp_f32 v55, v55
    v_exp_f32 v56, v56
    v_exp_f32 v57, v57
    v_smfmac_f32_32x32x32_bf16 v[128:143], v[20:23], v[48:55], v7
    v_exp_f32 v58, v58
    v_exp_f32 v59, v59
    v_exp_f32 v60, v60
    v_exp_f32 v61, v61
    v_exp_f32 v62, v62
    v_exp_f32 v63, v63
    s_setprio 2
    s_waitcnt lgkmcnt(0)
    v_exp_f32 v32, v32
    ds_read_b128 v[8:11], v4 offset:4096
    v_exp_f32 v33, v33
    v_smfmac_f32_32x32x32_bf16 v[128:143], v[28:31], v[56:63], v7
    s_mov_b64 exec, s[10:11]
    ds_read_b128 v[20:23], v5 offset:3072
    ds_read_b128 v[28:31], v5 offset:3584
    s_mov_b64 exec, -1
    v_exp_f32 v34, v34
    v_exp_f32 v35, v35
    v_exp_f32 v36, v36
    v_mfma_f32_32x32x16_bf16 v[48:63], v[12:15], v[156:159], v[96:111]
    v_exp_f32 v37, v37
    v_exp_f32 v38, v38
    v_exp_f32 v39, v39
    v_exp_f32 v40, v40
    v_exp_f32 v41, v41
    v_smfmac_f32_32x32x32_bf16 v[128:143], v[16:19], v[32:39], v7
    v_exp_f32 v42, v42
    v_exp_f32 v43, v43
    v_exp_f32 v44, v44
    v_exp_f32 v45, v45
    v_exp_f32 v46, v46
    v_exp_f32 v47, v47
    s_waitcnt lgkmcnt(0)
    v_exp_f32 v48, v48
    ds_read_b128 v[12:15], v4 offset:5120
    v_exp_f32 v49, v49
    v_smfmac_f32_32x32x32_bf16 v[128:143], v[24:27], v[40:47], v7
    s_mov_b64 exec, s[10:11]
    ds_read_b128 v[16:19], v5 offset:4096
    ds_read_b128 v[24:27], v5 offset:4608
    s_mov_b64 exec, -1
    v_exp_f32 v50, v50
    v_exp_f32 v51, v51
    v_exp_f32 v52, v52
    v_mfma_f32_32x32x16_bf16 v[32:47], v[8:11], v[156:159], v[96:111]
    v_exp_f32 v53, v53
    v_exp_f32 v54, v54
    v_exp_f32 v55, v55
    v_exp_f32 v56, v56
    v_exp_f32 v57, v57
    v_smfmac_f32_32x32x32_bf16 v[128:143], v[20:23], v[48:55], v7
    v_exp_f32 v58, v58
    v_exp_f32 v59, v59
    v_exp_f32 v60, v60
    v_exp_f32 v61, v61
    v_exp_f32 v62, v62
    v_exp_f32 v63, v63
    s_waitcnt lgkmcnt(0)
    v_exp_f32 v32, v32
    ds_read_b128 v[8:11], v4 offset:6144
    v_exp_f32 v33, v33
    v_smfmac_f32_32x32x32_bf16 v[128:143], v[28:31], v[56:63], v7
    s_mov_b64 exec, s[10:11]
    ds_read_b128 v[20:23], v5 offset:5120
    ds_read_b128 v[28:31], v5 offset:5632
    s_mov_b64 exec, -1
    v_exp_f32 v34, v34
    v_exp_f32 v35, v35
    v_exp_f32 v36, v36
    v_mfma_f32_32x32x16_bf16 v[48:63], v[12:15], v[156:159], v[96:111]
    v_exp_f32 v37, v37
    v_exp_f32 v38, v38
    v_exp_f32 v39, v39
    v_exp_f32 v40, v40
    v_exp_f32 v41, v41
    v_smfmac_f32_32x32x32_bf16 v[128:143], v[16:19], v[32:39], v7
    v_exp_f32 v42, v42
    v_exp_f32 v43, v43
    v_exp_f32 v44, v44
    v_exp_f32 v45, v45
    v_exp_f32 v46, v46
    v_exp_f32 v47, v47
    s_waitcnt lgkmcnt(0)
    v_exp_f32 v48, v48
    ds_read_b128 v[12:15], v4 offset:7168
    v_exp_f32 v49, v49
    v_smfmac_f32_32x32x32_bf16 v[128:143], v[24:27], v[40:47], v7
    s_mov_b64 exec, s[10:11]
    ds_read_b128 v[16:19], v5 offset:6144
    ds_read_b128 v[24:27], v5 offset:6656
    s_mov_b64 exec, -1
    v_exp_f32 v50, v50
    v_exp_f32 v51, v51
    v_exp_f32 v52, v52
    v_mfma_f32_32x32x16_bf16 v[32:47], v[8:11], v[156:159], v[96:111]
    v_exp_f32 v53, v53
    v_exp_f32 v54, v54
    v_exp_f32 v55, v55
    v_exp_f32 v56, v56
    v_exp_f32 v57, v57
    v_smfmac_f32_32x32x32_bf16 v[128:143], v[20:23], v[48:55], v7
    v_exp_f32 v58, v58
    v_exp_f32 v59, v59
    v_exp_f32 v60, v60
    v_exp_f32 v61, v61
    v_exp_f32 v62, v62
    v_exp_f32 v63, v63
    s_waitcnt lgkmcnt(0)
    v_exp_f32 v32, v32
    v_exp_f32 v33, v33
    v_smfmac_f32_32x32x32_bf16 v[128:143], v[28:31], v[56:63], v7
    s_mov_b64 exec, s[10:11]
    ds_read_b128 v[20:23], v5 offset:7168
    ds_read_b128 v[28:31], v5 offset:7680
    s_mov_b64 exec, -1
    v_exp_f32 v34, v34
    v_exp_f32 v35, v35
    v_exp_f32 v36, v36
    v_mfma_f32_32x32x16_bf16 v[48:63], v[12:15], v[156:159], v[96:111]
    v_exp_f32 v37, v37
    v_exp_f32 v38, v38
    v_exp_f32 v39, v39
    v_exp_f32 v40, v40
    v_exp_f32 v41, v41
    v_smfmac_f32_32x32x32_bf16 v[128:143], v[16:19], v[32:39], v7
    v_exp_f32 v42, v42
    v_exp_f32 v43, v43
    v_exp_f32 v44, v44
    v_exp_f32 v45, v45
    v_exp_f32 v46, v46
    v_exp_f32 v47, v47
    s_setprio 1
    s_waitcnt lgkmcnt(0)
    v_exp_f32 v48, v48
    v_exp_f32 v49, v49
    v_smfmac_f32_32x32x32_bf16 v[128:143], v[24:27], v[40:47], v7
    v_exp_f32 v50, v50
    v_exp_f32 v51, v51
    v_exp_f32 v52, v52
    v_exp_f32 v53, v53
    v_exp_f32 v54, v54
    v_exp_f32 v55, v55
    v_exp_f32 v56, v56
    v_exp_f32 v57, v57
    v_smfmac_f32_32x32x32_bf16 v[128:143], v[20:23], v[48:55], v7
    v_exp_f32 v58, v58
    v_exp_f32 v59, v59
    v_exp_f32 v60, v60
    v_exp_f32 v61, v61
    v_exp_f32 v62, v62
    v_exp_f32 v63, v63
    s_nop 1
    v_smfmac_f32_32x32x32_bf16 v[128:143], v[28:31], v[56:63], v7
    s_mov_b32 s20, s38
    s_nop 0
    s_nop 7
    s_nop 3
    v_rcp_f32 v68, v136
    v_fma_f32 v69, 0, v128, v136
    v_fmac_f32 v69, 0, v129
    v_fmac_f32 v69, 0, v130
    v_fmac_f32 v69, 0, v131
    v_fmac_f32 v69, 0, v132
    v_fmac_f32 v69, 0, v133
    v_fmac_f32 v69, 0, v134
    v_fmac_f32 v69, 0, v135
    v_cmp_nlt_f32 s[46:47], v69, s43
    v_mul_f32 v128, v128, v68
    v_mul_f32 v129, v129, v68
    v_mul_f32 v130, v130, v68
    v_mul_f32 v131, v131, v68
    v_mul_f32 v132, v132, v68
    v_mul_f32 v133, v133, v68
    v_mul_f32 v134, v134, v68
    v_mul_f32 v135, v135, v68
    v_cvt_pk_bf16_f32 v32, v128, v129
    v_cvt_pk_bf16_f32 v33, v130, v131
    v_cvt_pk_bf16_f32 v34, v132, v133
    v_cvt_pk_bf16_f32 v35, v134, v135
    v_min_u32 v32, -2, v32
    v_min_u32 v33, -2, v33
    v_min_u32 v34, -2, v34
    v_min_u32 v35, -2, v35
    s_or_b64 s[46:47], s[46:47], s[44:45]
    s_cbranch_scc1 .L_fallback
    buffer_store_dwordx4 v[32:35], v3, s[12:15], s59 offen sc1
.L_final:
    s_setprio 0
    v_bfe_u32 v6, v2, 2, 2
    v_lshrrev_b32 v9, 5, v2
    v_lshl_add_u32 v8, v9, 2, v6
    v_lshlrev_b32 v8, 7, v8
    v_and_b32 v7, 1, v2
    v_lshlrev_b32 v7, 1, v7
    v_bfe_u32 v12, v2, 4, 1
    v_add_u32 v7, v7, v12
    v_and_b32 v12, 2, v6
    v_lshl_add_u32 v7, v12, 1, v7
    v_bfe_u32 v12, v2, 1, 1
    v_lshl_add_u32 v8, v12, 3, v8
    v_lshl_add_u32 v12, v7, 4, v8
    s_lshl_b32 s32, s28, 15
    s_add_u32 s32, s32, 98304
    v_add_u32 v12, s32, v12
    v_xor_b32 v13, 64, v12
    s_and_b32 s56, s38, 3
    s_mul_i32 s56, s56, 17408
    s_mul_i32 s57, s28, 8704
    s_add_u32 s57, s57, s56
    v_and_b32 v4, 31, v2
    v_mul_u32_u24 v4, 272, v4
    v_lshl_add_u32 v4, v9, 6, v4
    v_add_u32 v4, s57, v4
    s_mul_i32 s57, s28, 4352
    s_add_u32 s57, s57, s56
    v_lshrrev_b32 v6, 3, v2
    v_and_b32 v8, 7, v2
    v_mul_u32_u24 v7, 272, v6
    v_lshl_add_u32 v7, v8, 5, v7
    v_add_u32 v7, s57, v7
    v_lshlrev_b32 v6, 11, v6
    v_lshl_add_u32 v6, v8, 4, v6
    s_mov_b32 s16, s48
    s_mov_b32 s17, s49
    s_mov_b32 s18, 4194304
    s_mov_b32 s19, 0x00020000
    s_lshl_b32 s33, s20, 16
    s_lshl_b32 s32, s22, 10
    s_add_u32 s33, s33, s32
    s_lshr_b32 s32, s25, 1
    s_lshl_b32 s32, s32, 7
    s_add_u32 s33, s33, s32
    s_lshl_b32 s32, s28, 15
    s_add_u32 s33, s33, s32
    s_add_u32 s36, s33, 16384
    s_mov_b32 s35, 0
    s_mov_b32 s30, 0xffff
    s_barrier
    s_bitcmp1_b32 s38, 0
    s_cbranch_scc0 .L_p3_noE3
    s_barrier
.L_p3_noE3:
    s_add_u32 s21, s34, s4
    buffer_load_dwordx4 v[16:19], v3, s[12:15], s21 offen offset:0 sc1
    buffer_load_dwordx4 v[20:23], v3, s[12:15], s21 offen offset:1024 sc1
    buffer_load_dwordx4 v[24:27], v3, s[12:15], s21 offen offset:2048 sc1
    buffer_load_dwordx4 v[28:31], v3, s[12:15], s21 offen offset:3072 sc1
    s_add_u32 s21, s34, s5
    buffer_load_dwordx4 v[32:35], v3, s[12:15], s21 offen offset:0 sc1
    buffer_load_dwordx4 v[36:39], v3, s[12:15], s21 offen offset:1024 sc1
    buffer_load_dwordx4 v[40:43], v3, s[12:15], s21 offen offset:2048 sc1
    buffer_load_dwordx4 v[44:47], v3, s[12:15], s21 offen offset:3072 sc1
    s_add_u32 s21, s34, s6
    buffer_load_dwordx4 v[48:51], v3, s[12:15], s21 offen offset:0 sc1
    buffer_load_dwordx4 v[52:55], v3, s[12:15], s21 offen offset:1024 sc1
    buffer_load_dwordx4 v[56:59], v3, s[12:15], s21 offen offset:2048 sc1
    buffer_load_dwordx4 v[60:63], v3, s[12:15], s21 offen offset:3072 sc1
    s_add_u32 s21, s34, s7
    buffer_load_dwordx4 v[64:67], v3, s[12:15], s21 offen offset:0 sc1
    buffer_load_dwordx4 v[68:71], v3, s[12:15], s21 offen offset:1024 sc1
    buffer_load_dwordx4 v[72:75], v3, s[12:15], s21 offen offset:2048 sc1
    buffer_load_dwordx4 v[76:79], v3, s[12:15], s21 offen offset:3072 sc1
.L_p3_have:
    ds_read_b64_tr_b16 v[80:81], v12 offset:0
    ds_read_b64_tr_b16 v[82:83], v12 offset:1024
    ds_read_b64_tr_b16 v[84:85], v13 offset:0
    ds_read_b64_tr_b16 v[86:87], v13 offset:1024
    v_mov_b32 v14, 0
    ds_read_b64_tr_b16 v[88:89], v12 offset:2048
    ds_read_b64_tr_b16 v[90:91], v12 offset:3072
    ds_read_b64_tr_b16 v[92:93], v13 offset:2048
    ds_read_b64_tr_b16 v[94:95], v13 offset:3072
    s_waitcnt vmcnt(15) lgkmcnt(4)
    v_mfma_f32_32x32x16_bf16 v[96:111], v[80:83], v[16:19], 0
    v_max3_u32 v14, v14, v16, v17
    v_mfma_f32_32x32x16_bf16 v[112:127], v[84:87], v[16:19], 0
    v_max3_u32 v14, v14, v18, v19
    ds_read_b64_tr_b16 v[80:81], v12 offset:4096
    ds_read_b64_tr_b16 v[82:83], v12 offset:5120
    ds_read_b64_tr_b16 v[84:85], v13 offset:4096
    ds_read_b64_tr_b16 v[86:87], v13 offset:5120
    s_waitcnt vmcnt(14) lgkmcnt(4)
    v_mfma_f32_32x32x16_bf16 v[96:111], v[88:91], v[20:23], v[96:111]
    v_max3_u32 v14, v14, v20, v21
    v_mfma_f32_32x32x16_bf16 v[112:127], v[92:95], v[20:23], v[112:127]
    v_max3_u32 v14, v14, v22, v23
    ds_read_b64_tr_b16 v[88:89], v12 offset:6144
    ds_read_b64_tr_b16 v[90:91], v12 offset:7168
    ds_read_b64_tr_b16 v[92:93], v13 offset:6144
    ds_read_b64_tr_b16 v[94:95], v13 offset:7168
    s_waitcnt vmcnt(13) lgkmcnt(4)
    v_mfma_f32_32x32x16_bf16 v[96:111], v[80:83], v[24:27], v[96:111]
    v_max3_u32 v14, v14, v24, v25
    v_mfma_f32_32x32x16_bf16 v[112:127], v[84:87], v[24:27], v[112:127]
    v_max3_u32 v14, v14, v26, v27
    ds_read_b64_tr_b16 v[80:81], v12 offset:8192
    ds_read_b64_tr_b16 v[82:83], v12 offset:9216
    ds_read_b64_tr_b16 v[84:85], v13 offset:8192
    ds_read_b64_tr_b16 v[86:87], v13 offset:9216
    s_waitcnt vmcnt(12) lgkmcnt(4)
    v_mfma_f32_32x32x16_bf16 v[96:111], v[88:91], v[28:31], v[96:111]
    v_max3_u32 v14, v14, v28, v29
    v_mfma_f32_32x32x16_bf16 v[112:127], v[92:95], v[28:31], v[112:127]
    v_max3_u32 v14, v14, v30, v31
    ds_read_b64_tr_b16 v[88:89], v12 offset:10240
    ds_read_b64_tr_b16 v[90:91], v12 offset:11264
    ds_read_b64_tr_b16 v[92:93], v13 offset:10240
    ds_read_b64_tr_b16 v[94:95], v13 offset:11264
    s_waitcnt vmcnt(11) lgkmcnt(4)
    v_mfma_f32_32x32x16_bf16 v[96:111], v[80:83], v[32:35], v[96:111]
    v_max3_u32 v14, v14, v32, v33
    v_mfma_f32_32x32x16_bf16 v[112:127], v[84:87], v[32:35], v[112:127]
    v_max3_u32 v14, v14, v34, v35
    ds_read_b64_tr_b16 v[80:81], v12 offset:12288
    ds_read_b64_tr_b16 v[82:83], v12 offset:13312
    ds_read_b64_tr_b16 v[84:85], v13 offset:12288
    ds_read_b64_tr_b16 v[86:87], v13 offset:13312
    s_waitcnt vmcnt(10) lgkmcnt(4)
    v_mfma_f32_32x32x16_bf16 v[96:111], v[88:91], v[36:39], v[96:111]
    v_max3_u32 v14, v14, v36, v37
    v_mfma_f32_32x32x16_bf16 v[112:127], v[92:95], v[36:39], v[112:127]
    v_max3_u32 v14, v14, v38, v39
    ds_read_b64_tr_b16 v[88:89], v12 offset:14336
    ds_read_b64_tr_b16 v[90:91], v12 offset:15360
    ds_read_b64_tr_b16 v[92:93], v13 offset:14336
    ds_read_b64_tr_b16 v[94:95], v13 offset:15360
    s_waitcnt vmcnt(9) lgkmcnt(4)
    v_mfma_f32_32x32x16_bf16 v[96:111], v[80:83], v[40:43], v[96:111]
    v_max3_u32 v14, v14, v40, v41
    v_mfma_f32_32x32x16_bf16 v[112:127], v[84:87], v[40:43], v[112:127]
    v_max3_u32 v14, v14, v42, v43
    ds_read_b64_tr_b16 v[80:81], v12 offset:16384
    ds_read_b64_tr_b16 v[82:83], v12 offset:17408
    ds_read_b64_tr_b16 v[84:85], v13 offset:16384
    ds_read_b64_tr_b16 v[86:87], v13 offset:17408
    s_waitcnt vmcnt(8) lgkmcnt(4)
    v_mfma_f32_32x32x16_bf16 v[96:111], v[88:91], v[44:47], v[96:111]
    v_max3_u32 v14, v14, v44, v45
    v_mfma_f32_32x32x16_bf16 v[112:127], v[92:95], v[44:47], v[112:127]
    v_max3_u32 v14, v14, v46, v47
    ds_read_b64_tr_b16 v[88:89], v12 offset:18432
    ds_read_b64_tr_b16 v[90:91], v12 offset:19456
    ds_read_b64_tr_b16 v[92:93], v13 offset:18432
    ds_read_b64_tr_b16 v[94:95], v13 offset:19456
    s_waitcnt vmcnt(7) lgkmcnt(4)
    v_mfma_f32_32x32x16_bf16 v[96:111], v[80:83], v[48:51], v[96:111]
    v_max3_u32 v14, v14, v48, v49
    v_mfma_f32_32x32x16_bf16 v[112:127], v[84:87], v[48:51], v[112:127]
    v_max3_u32 v14, v14, v50, v51
    ds_read_b64_tr_b16 v[80:81], v12 offset:20480
    ds_read_b64_tr_b16 v[82:83], v12 offset:21504
    ds_read_b64_tr_b16 v[84:85], v13 offset:20480
    ds_read_b64_tr_b16 v[86:87], v13 offset:21504
    s_waitcnt vmcnt(6) lgkmcnt(4)
    v_mfma_f32_32x32x16_bf16 v[96:111], v[88:91], v[52:55], v[96:111]
    v_max3_u32 v14, v14, v52, v53
    v_mfma_f32_32x32x16_bf16 v[112:127], v[92:95], v[52:55], v[112:127]
    v_max3_u32 v14, v14, v54, v55
    ds_read_b64_tr_b16 v[88:89], v12 offset:22528
    ds_read_b64_tr_b16 v[90:91], v12 offset:23552
    ds_read_b64_tr_b16 v[92:93], v13 offset:22528
    ds_read_b64_tr_b16 v[94:95], v13 offset:23552
    s_waitcnt vmcnt(5) lgkmcnt(4)
    v_mfma_f32_32x32x16_bf16 v[96:111], v[80:83], v[56:59], v[96:111]
    v_max3_u32 v14, v14, v56, v57
    v_mfma_f32_32x32x16_bf16 v[112:127], v[84:87], v[56:59], v[112:127]
    v_max3_u32 v14, v14, v58, v59
    ds_read_b64_tr_b16 v[80:81], v12 offset:24576
    ds_read_b64_tr_b16 v[82:83], v12 offset:25600
    ds_read_b64_tr_b16 v[84:85], v13 offset:24576
    ds_read_b64_tr_b16 v[86:87], v13 offset:25600
    s_waitcnt vmcnt(4) lgkmcnt(4)
    v_mfma_f32_32x32x16_bf16 v[96:111], v[88:91], v[60:63], v[96:111]
    v_max3_u32 v14, v14, v60, v61
    v_mfma_f32_32x32x16_bf16 v[112:127], v[92:95], v[60:63], v[112:127]
    v_max3_u32 v14, v14, v62, v63
    ds_read_b64_tr_b16 v[88:89], v12 offset:26624
    ds_read_b64_tr_b16 v[90:91], v12 offset:27648
    ds_read_b64_tr_b16 v[92:93], v13 offset:26624
    ds_read_b64_tr_b16 v[94:95], v13 offset:27648
    s_waitcnt vmcnt(3) lgkmcnt(4)
    v_mfma_f32_32x32x16_bf16 v[96:111], v[80:83], v[64:67], v[96:111]
    v_max3_u32 v14, v14, v64, v65
    v_mfma_f32_32x32x16_bf16 v[112:127], v[84:87], v[64:67], v[112:127]
    v_max3_u32 v14, v14, v66, v67
    ds_read_b64_tr_b16 v[80:81], v12 offset:28672
    ds_read_b64_tr_b16 v[82:83], v12 offset:29696
    ds_read_b64_tr_b16 v[84:85], v13 offset:28672
    ds_read_b64_tr_b16 v[86:87], v13 offset:29696
    s_waitcnt vmcnt(2) lgkmcnt(4)
    v_mfma_f32_32x32x16_bf16 v[96:111], v[88:91], v[68:71], v[96:111]
    v_max3_u32 v14, v14, v68, v69
    v_mfma_f32_32x32x16_bf16 v[112:127], v[92:95], v[68:71], v[112:127]
    v_max3_u32 v14, v14, v70, v71
    ds_read_b64_tr_b16 v[88:89], v12 offset:30720
    ds_read_b64_tr_b16 v[90:91], v12 offset:31744
    ds_read_b64_tr_b16 v[92:93], v13 offset:30720
    ds_read_b64_tr_b16 v[94:95], v13 offset:31744
    s_waitcnt vmcnt(1) lgkmcnt(4)
    v_mfma_f32_32x32x16_bf16 v[96:111], v[80:83], v[72:75], v[96:111]
    v_max3_u32 v14, v14, v72, v73
    v_mfma_f32_32x32x16_bf16 v[112:127], v[84:87], v[72:75], v[112:127]
    v_max3_u32 v14, v14, v74, v75
    s_waitcnt vmcnt(0) lgkmcnt(0)
    v_mfma_f32_32x32x16_bf16 v[96:111], v[88:91], v[76:79], v[96:111]
    v_max3_u32 v14, v14, v76, v77
    v_mfma_f32_32x32x16_bf16 v[112:127], v[92:95], v[76:79], v[112:127]
    v_max3_u32 v14, v14, v78, v79
    v_cmp_eq_u32 vcc, -1, v14
    s_cbranch_vccz .L_p3_ok
    s_nop 7
    s_nop 3
    v_mov_b32 v96, 0
    v_mov_b32 v97, 0
    v_mov_b32 v98, 0
    v_mov_b32 v99, 0
    v_mov_b32 v100, 0
    v_mov_b32 v101, 0
    v_mov_b32 v102, 0
    v_mov_b32 v103, 0
    v_mov_b32 v104, 0
    v_mov_b32 v105, 0
    v_mov_b32 v106, 0
    v_mov_b32 v107, 0
    v_mov_b32 v108, 0
    v_mov_b32 v109, 0
    v_mov_b32 v110, 0
    v_mov_b32 v111, 0
    v_mov_b32 v112, 0
    v_mov_b32 v113, 0
    v_mov_b32 v114, 0
    v_mov_b32 v115, 0
    v_mov_b32 v116, 0
    v_mov_b32 v117, 0
    v_mov_b32 v118, 0
    v_mov_b32 v119, 0
    v_mov_b32 v120, 0
    v_mov_b32 v121, 0
    v_mov_b32 v122, 0
    v_mov_b32 v123, 0
    v_mov_b32 v124, 0
    v_mov_b32 v125, 0
    v_mov_b32 v126, 0
    v_mov_b32 v127, 0
    s_cmp_eq_u32 s30, 0
    s_cbranch_scc1 .L_p3_ok
.L_p3_round:
    s_add_u32 s21, s34, s4
    s_bitcmp1_b32 s30, 0
    s_cselect_b32 s31, s21, 0x40000000
    buffer_load_dwordx4 v[16:19], v3, s[12:15], s31 offen offset:0 sc1
    s_bitcmp1_b32 s30, 1
    s_cselect_b32 s31, s21, 0x40000000
    buffer_load_dwordx4 v[20:23], v3, s[12:15], s31 offen offset:1024 sc1
    s_bitcmp1_b32 s30, 2
    s_cselect_b32 s31, s21, 0x40000000
    buffer_load_dwordx4 v[24:27], v3, s[12:15], s31 offen offset:2048 sc1
    s_bitcmp1_b32 s30, 3
    s_cselect_b32 s31, s21, 0x40000000
    buffer_load_dwordx4 v[28:31], v3, s[12:15], s31 offen offset:3072 sc1
    s_add_u32 s21, s34, s5
    s_bitcmp1_b32 s30, 4
    s_cselect_b32 s31, s21, 0x40000000
    buffer_load_dwordx4 v[32:35], v3, s[12:15], s31 offen offset:0 sc1
    s_bitcmp1_b32 s30, 5
    s_cselect_b32 s31, s21, 0x40000000
    buffer_load_dwordx4 v[36:39], v3, s[12:15], s31 offen offset:1024 sc1
    s_bitcmp1_b32 s30, 6
    s_cselect_b32 s31, s21, 0x40000000
    buffer_load_dwordx4 v[40:43], v3, s[12:15], s31 offen offset:2048 sc1
    s_bitcmp1_b32 s30, 7
    s_cselect_b32 s31, s21, 0x40000000
    buffer_load_dwordx4 v[44:47], v3, s[12:15], s31 offen offset:3072 sc1
    s_add_u32 s21, s34, s6
    s_bitcmp1_b32 s30, 8
    s_cselect_b32 s31, s21, 0x40000000
    buffer_load_dwordx4 v[48:51], v3, s[12:15], s31 offen offset:0 sc1
    s_bitcmp1_b32 s30, 9
    s_cselect_b32 s31, s21, 0x40000000
    buffer_load_dwordx4 v[52:55], v3, s[12:15], s31 offen offset:1024 sc1
    s_bitcmp1_b32 s30, 10
    s_cselect_b32 s31, s21, 0x40000000
    buffer_load_dwordx4 v[56:59], v3, s[12:15], s31 offen offset:2048 sc1
    s_bitcmp1_b32 s30, 11
    s_cselect_b32 s31, s21, 0x40000000
    buffer_load_dwordx4 v[60:63], v3, s[12:15], s31 offen offset:3072 sc1
    s_add_u32 s21, s34, s7
    s_bitcmp1_b32 s30, 12
    s_cselect_b32 s31, s21, 0x40000000
    buffer_load_dwordx4 v[64:67], v3, s[12:15], s31 offen offset:0 sc1
    s_bitcmp1_b32 s30, 13
    s_cselect_b32 s31, s21, 0x40000000
    buffer_load_dwordx4 v[68:71], v3, s[12:15], s31 offen offset:1024 sc1
    s_bitcmp1_b32 s30, 14
    s_cselect_b32 s31, s21, 0x40000000
    buffer_load_dwordx4 v[72:75], v3, s[12:15], s31 offen offset:2048 sc1
    s_bitcmp1_b32 s30, 15
    s_cselect_b32 s31, s21, 0x40000000
    buffer_load_dwordx4 v[76:79], v3, s[12:15], s31 offen offset:3072 sc1
    s_bitcmp1_b32 s30, 0
    s_cbranch_scc0 .L_p3_n0
    ds_read_b64_tr_b16 v[80:81], v12 offset:0
    ds_read_b64_tr_b16 v[82:83], v12 offset:1024
    ds_read_b64_tr_b16 v[84:85], v13 offset:0
    ds_read_b64_tr_b16 v[86:87], v13 offset:1024
    s_waitcnt vmcnt(15)
    v_max3_u32 v14, v16, v17, v18
    v_max_u32 v14, v14, v19
    v_cmp_eq_u32 vcc, -1, v14
    s_waitcnt lgkmcnt(0)
    s_cbranch_vccnz .L_p3_n0
    v_mfma_f32_32x32x16_bf16 v[96:111], v[80:83], v[16:19], v[96:111]
    v_mfma_f32_32x32x16_bf16 v[112:127], v[84:87], v[16:19], v[112:127]
    s_bitset0_b32 s30, 0
.L_p3_n0:
    s_bitcmp1_b32 s30, 1
    s_cbranch_scc0 .L_p3_n1
    ds_read_b64_tr_b16 v[88:89], v12 offset:2048
    ds_read_b64_tr_b16 v[90:91], v12 offset:3072
    ds_read_b64_tr_b16 v[92:93], v13 offset:2048
    ds_read_b64_tr_b16 v[94:95], v13 offset:3072
    s_waitcnt vmcnt(14)
    v_max3_u32 v14, v20, v21, v22
    v_max_u32 v14, v14, v23
    v_cmp_eq_u32 vcc, -1, v14
    s_waitcnt lgkmcnt(0)
    s_cbranch_vccnz .L_p3_n1
    v_mfma_f32_32x32x16_bf16 v[96:111], v[88:91], v[20:23], v[96:111]
    v_mfma_f32_32x32x16_bf16 v[112:127], v[92:95], v[20:23], v[112:127]
    s_bitset0_b32 s30, 1
.L_p3_n1:
    s_bitcmp1_b32 s30, 2
    s_cbranch_scc0 .L_p3_n2
    ds_read_b64_tr_b16 v[80:81], v12 offset:4096
    ds_read_b64_tr_b16 v[82:83], v12 offset:5120
    ds_read_b64_tr_b16 v[84:85], v13 offset:4096
    ds_read_b64_tr_b16 v[86:87], v13 offset:5120
    s_waitcnt vmcnt(13)
    v_max3_u32 v14, v24, v25, v26
    v_max_u32 v14, v14, v27
    v_cmp_eq_u32 vcc, -1, v14
    s_waitcnt lgkmcnt(0)
    s_cbranch_vccnz .L_p3_n2
    v_mfma_f32_32x32x16_bf16 v[96:111], v[80:83], v[24:27], v[96:111]
    v_mfma_f32_32x32x16_bf16 v[112:127], v[84:87], v[24:27], v[112:127]
    s_bitset0_b32 s30, 2
.L_p3_n2:
    s_bitcmp1_b32 s30, 3
    s_cbranch_scc0 .L_p3_n3
    ds_read_b64_tr_b16 v[88:89], v12 offset:6144
    ds_read_b64_tr_b16 v[90:91], v12 offset:7168
    ds_read_b64_tr_b16 v[92:93], v13 offset:6144
    ds_read_b64_tr_b16 v[94:95], v13 offset:7168
    s_waitcnt vmcnt(12)
    v_max3_u32 v14, v28, v29, v30
    v_max_u32 v14, v14, v31
    v_cmp_eq_u32 vcc, -1, v14
    s_waitcnt lgkmcnt(0)
    s_cbranch_vccnz .L_p3_n3
    v_mfma_f32_32x32x16_bf16 v[96:111], v[88:91], v[28:31], v[96:111]
    v_mfma_f32_32x32x16_bf16 v[112:127], v[92:95], v[28:31], v[112:127]
    s_bitset0_b32 s30, 3
.L_p3_n3:
    s_bitcmp1_b32 s30, 4
    s_cbranch_scc0 .L_p3_n4
    ds_read_b64_tr_b16 v[80:81], v12 offset:8192
    ds_read_b64_tr_b16 v[82:83], v12 offset:9216
    ds_read_b64_tr_b16 v[84:85], v13 offset:8192
    ds_read_b64_tr_b16 v[86:87], v13 offset:9216
    s_waitcnt vmcnt(11)
    v_max3_u32 v14, v32, v33, v34
    v_max_u32 v14, v14, v35
    v_cmp_eq_u32 vcc, -1, v14
    s_waitcnt lgkmcnt(0)
    s_cbranch_vccnz .L_p3_n4
    v_mfma_f32_32x32x16_bf16 v[96:111], v[80:83], v[32:35], v[96:111]
    v_mfma_f32_32x32x16_bf16 v[112:127], v[84:87], v[32:35], v[112:127]
    s_bitset0_b32 s30, 4
.L_p3_n4:
    s_bitcmp1_b32 s30, 5
    s_cbranch_scc0 .L_p3_n5
    ds_read_b64_tr_b16 v[88:89], v12 offset:10240
    ds_read_b64_tr_b16 v[90:91], v12 offset:11264
    ds_read_b64_tr_b16 v[92:93], v13 offset:10240
    ds_read_b64_tr_b16 v[94:95], v13 offset:11264
    s_waitcnt vmcnt(10)
    v_max3_u32 v14, v36, v37, v38
    v_max_u32 v14, v14, v39
    v_cmp_eq_u32 vcc, -1, v14
    s_waitcnt lgkmcnt(0)
    s_cbranch_vccnz .L_p3_n5
    v_mfma_f32_32x32x16_bf16 v[96:111], v[88:91], v[36:39], v[96:111]
    v_mfma_f32_32x32x16_bf16 v[112:127], v[92:95], v[36:39], v[112:127]
    s_bitset0_b32 s30, 5
.L_p3_n5:
    s_bitcmp1_b32 s30, 6
    s_cbranch_scc0 .L_p3_n6
    ds_read_b64_tr_b16 v[80:81], v12 offset:12288
    ds_read_b64_tr_b16 v[82:83], v12 offset:13312
    ds_read_b64_tr_b16 v[84:85], v13 offset:12288
    ds_read_b64_tr_b16 v[86:87], v13 offset:13312
    s_waitcnt vmcnt(9)
    v_max3_u32 v14, v40, v41, v42
    v_max_u32 v14, v14, v43
    v_cmp_eq_u32 vcc, -1, v14
    s_waitcnt lgkmcnt(0)
    s_cbranch_vccnz .L_p3_n6
    v_mfma_f32_32x32x16_bf16 v[96:111], v[80:83], v[40:43], v[96:111]
    v_mfma_f32_32x32x16_bf16 v[112:127], v[84:87], v[40:43], v[112:127]
    s_bitset0_b32 s30, 6
.L_p3_n6:
    s_bitcmp1_b32 s30, 7
    s_cbranch_scc0 .L_p3_n7
    ds_read_b64_tr_b16 v[88:89], v12 offset:14336
    ds_read_b64_tr_b16 v[90:91], v12 offset:15360
    ds_read_b64_tr_b16 v[92:93], v13 offset:14336
    ds_read_b64_tr_b16 v[94:95], v13 offset:15360
    s_waitcnt vmcnt(8)
    v_max3_u32 v14, v44, v45, v46
    v_max_u32 v14, v14, v47
    v_cmp_eq_u32 vcc, -1, v14
    s_waitcnt lgkmcnt(0)
    s_cbranch_vccnz .L_p3_n7
    v_mfma_f32_32x32x16_bf16 v[96:111], v[88:91], v[44:47], v[96:111]
    v_mfma_f32_32x32x16_bf16 v[112:127], v[92:95], v[44:47], v[112:127]
    s_bitset0_b32 s30, 7
.L_p3_n7:
    s_bitcmp1_b32 s30, 8
    s_cbranch_scc0 .L_p3_n8
    ds_read_b64_tr_b16 v[80:81], v12 offset:16384
    ds_read_b64_tr_b16 v[82:83], v12 offset:17408
    ds_read_b64_tr_b16 v[84:85], v13 offset:16384
    ds_read_b64_tr_b16 v[86:87], v13 offset:17408
    s_waitcnt vmcnt(7)
    v_max3_u32 v14, v48, v49, v50
    v_max_u32 v14, v14, v51
    v_cmp_eq_u32 vcc, -1, v14
    s_waitcnt lgkmcnt(0)
    s_cbranch_vccnz .L_p3_n8
    v_mfma_f32_32x32x16_bf16 v[96:111], v[80:83], v[48:51], v[96:111]
    v_mfma_f32_32x32x16_bf16 v[112:127], v[84:87], v[48:51], v[112:127]
    s_bitset0_b32 s30, 8
.L_p3_n8:
    s_bitcmp1_b32 s30, 9
    s_cbranch_scc0 .L_p3_n9
    ds_read_b64_tr_b16 v[88:89], v12 offset:18432
    ds_read_b64_tr_b16 v[90:91], v12 offset:19456
    ds_read_b64_tr_b16 v[92:93], v13 offset:18432
    ds_read_b64_tr_b16 v[94:95], v13 offset:19456
    s_waitcnt vmcnt(6)
    v_max3_u32 v14, v52, v53, v54
    v_max_u32 v14, v14, v55
    v_cmp_eq_u32 vcc, -1, v14
    s_waitcnt lgkmcnt(0)
    s_cbranch_vccnz .L_p3_n9
    v_mfma_f32_32x32x16_bf16 v[96:111], v[88:91], v[52:55], v[96:111]
    v_mfma_f32_32x32x16_bf16 v[112:127], v[92:95], v[52:55], v[112:127]
    s_bitset0_b32 s30, 9
.L_p3_n9:
    s_bitcmp1_b32 s30, 10
    s_cbranch_scc0 .L_p3_n10
    ds_read_b64_tr_b16 v[80:81], v12 offset:20480
    ds_read_b64_tr_b16 v[82:83], v12 offset:21504
    ds_read_b64_tr_b16 v[84:85], v13 offset:20480
    ds_read_b64_tr_b16 v[86:87], v13 offset:21504
    s_waitcnt vmcnt(5)
    v_max3_u32 v14, v56, v57, v58
    v_max_u32 v14, v14, v59
    v_cmp_eq_u32 vcc, -1, v14
    s_waitcnt lgkmcnt(0)
    s_cbranch_vccnz .L_p3_n10
    v_mfma_f32_32x32x16_bf16 v[96:111], v[80:83], v[56:59], v[96:111]
    v_mfma_f32_32x32x16_bf16 v[112:127], v[84:87], v[56:59], v[112:127]
    s_bitset0_b32 s30, 10
.L_p3_n10:
    s_bitcmp1_b32 s30, 11
    s_cbranch_scc0 .L_p3_n11
    ds_read_b64_tr_b16 v[88:89], v12 offset:22528
    ds_read_b64_tr_b16 v[90:91], v12 offset:23552
    ds_read_b64_tr_b16 v[92:93], v13 offset:22528
    ds_read_b64_tr_b16 v[94:95], v13 offset:23552
    s_waitcnt vmcnt(4)
    v_max3_u32 v14, v60, v61, v62
    v_max_u32 v14, v14, v63
    v_cmp_eq_u32 vcc, -1, v14
    s_waitcnt lgkmcnt(0)
    s_cbranch_vccnz .L_p3_n11
    v_mfma_f32_32x32x16_bf16 v[96:111], v[88:91], v[60:63], v[96:111]
    v_mfma_f32_32x32x16_bf16 v[112:127], v[92:95], v[60:63], v[112:127]
    s_bitset0_b32 s30, 11
.L_p3_n11:
    s_bitcmp1_b32 s30, 12
    s_cbranch_scc0 .L_p3_n12
    ds_read_b64_tr_b16 v[80:81], v12 offset:24576
    ds_read_b64_tr_b16 v[82:83], v12 offset:25600
    ds_read_b64_tr_b16 v[84:85], v13 offset:24576
    ds_read_b64_tr_b16 v[86:87], v13 offset:25600
    s_waitcnt vmcnt(3)
    v_max3_u32 v14, v64, v65, v66
    v_max_u32 v14, v14, v67
    v_cmp_eq_u32 vcc, -1, v14
    s_waitcnt lgkmcnt(0)
    s_cbranch_vccnz .L_p3_n12
    v_mfma_f32_32x32x16_bf16 v[96:111], v[80:83], v[64:67], v[96:111]
    v_mfma_f32_32x32x16_bf16 v[112:127], v[84:87], v[64:67], v[112:127]
    s_bitset0_b32 s30, 12
.L_p3_n12:
    s_bitcmp1_b32 s30, 13
    s_cbranch_scc0 .L_p3_n13
    ds_read_b64_tr_b16 v[88:89], v12 offset:26624
    ds_read_b64_tr_b16 v[90:91], v12 offset:27648
    ds_read_b64_tr_b16 v[92:93], v13 offset:26624
    ds_read_b64_tr_b16 v[94:95], v13 offset:27648
    s_waitcnt vmcnt(2)
    v_max3_u32 v14, v68, v69, v70
    v_max_u32 v14, v14, v71
    v_cmp_eq_u32 vcc, -1, v14
    s_waitcnt lgkmcnt(0)
    s_cbranch_vccnz .L_p3_n13
    v_mfma_f32_32x32x16_bf16 v[96:111], v[88:91], v[68:71], v[96:111]
    v_mfma_f32_32x32x16_bf16 v[112:127], v[92:95], v[68:71], v[112:127]
    s_bitset0_b32 s30, 13
.L_p3_n13:
    s_bitcmp1_b32 s30, 14
    s_cbranch_scc0 .L_p3_n14
    ds_read_b64_tr_b16 v[80:81], v12 offset:28672
    ds_read_b64_tr_b16 v[82:83], v12 offset:29696
    ds_read_b64_tr_b16 v[84:85], v13 offset:28672
    ds_read_b64_tr_b16 v[86:87], v13 offset:29696
    s_waitcnt vmcnt(1)
    v_max3_u32 v14, v72, v73, v74
    v_max_u32 v14, v14, v75
    v_cmp_eq_u32 vcc, -1, v14
    s_waitcnt lgkmcnt(0)
    s_cbranch_vccnz .L_p3_n14
    v_mfma_f32_32x32x16_bf16 v[96:111], v[80:83], v[72:75], v[96:111]
    v_mfma_f32_32x32x16_bf16 v[112:127], v[84:87], v[72:75], v[112:127]
    s_bitset0_b32 s30, 14
.L_p3_n14:
    s_bitcmp1_b32 s30, 15
    s_cbranch_scc0 .L_p3_n15
    ds_read_b64_tr_b16 v[88:89], v12 offset:30720
    ds_read_b64_tr_b16 v[90:91], v12 offset:31744
    ds_read_b64_tr_b16 v[92:93], v13 offset:30720
    ds_read_b64_tr_b16 v[94:95], v13 offset:31744
    s_waitcnt vmcnt(0)
    v_max3_u32 v14, v76, v77, v78
    v_max_u32 v14, v14, v79
    v_cmp_eq_u32 vcc, -1, v14
    s_waitcnt lgkmcnt(0)
    s_cbranch_vccnz .L_p3_n15
    v_mfma_f32_32x32x16_bf16 v[96:111], v[88:91], v[76:79], v[96:111]
    v_mfma_f32_32x32x16_bf16 v[112:127], v[92:95], v[76:79], v[112:127]
    s_bitset0_b32 s30, 15
.L_p3_n15:
    s_add_u32 s35, s35, 1
    s_cmp_gt_u32 s35, 1048576
    s_cbranch_scc1 .L_p3_ok
    s_cmp_lg_u32 s30, 0
    s_cbranch_scc1 .L_p3_round
.L_p3_ok:
    s_waitcnt vmcnt(0)
    s_nop 9
    ds_write_b128 v4, v[96:99] offset:0
    ds_write_b128 v4, v[100:103] offset:16
    ds_write_b128 v4, v[104:107] offset:32
    ds_write_b128 v4, v[108:111] offset:48
    ds_write_b128 v4, v[112:115] offset:128
    ds_write_b128 v4, v[116:119] offset:144
    ds_write_b128 v4, v[120:123] offset:160
    ds_write_b128 v4, v[124:127] offset:176
    s_waitcnt lgkmcnt(0)
    s_barrier
    ds_read_b128 v[16:19], v7 offset:0
    ds_read_b128 v[20:23], v7 offset:16
    ds_read_b128 v[24:27], v7 offset:8704
    ds_read_b128 v[28:31], v7 offset:8720
    ds_read_b128 v[32:35], v7 offset:2176
    ds_read_b128 v[36:39], v7 offset:2192
    ds_read_b128 v[40:43], v7 offset:10880
    ds_read_b128 v[44:47], v7 offset:10896
    s_waitcnt lgkmcnt(4)
    v_add_f32 v16, v16, v24
    v_add_f32 v17, v17, v25
    v_add_f32 v18, v18, v26
    v_add_f32 v19, v19, v27
    v_add_f32 v20, v20, v28
    v_add_f32 v21, v21, v29
    v_add_f32 v22, v22, v30
    v_add_f32 v23, v23, v31
    v_cvt_pk_bf16_f32 v80, v16, v17
    v_cvt_pk_bf16_f32 v81, v18, v19
    v_cvt_pk_bf16_f32 v82, v20, v21
    v_cvt_pk_bf16_f32 v83, v22, v23
    buffer_store_dwordx4 v[80:83], v6, s[16:19], s33 offen sc1
    s_waitcnt lgkmcnt(0)
    v_add_f32 v32, v32, v40
    v_add_f32 v33, v33, v41
    v_add_f32 v34, v34, v42
    v_add_f32 v35, v35, v43
    v_add_f32 v36, v36, v44
    v_add_f32 v37, v37, v45
    v_add_f32 v38, v38, v46
    v_add_f32 v39, v39, v47
    v_cvt_pk_bf16_f32 v84, v32, v33
    v_cvt_pk_bf16_f32 v85, v34, v35
    v_cvt_pk_bf16_f32 v86, v36, v37
    v_cvt_pk_bf16_f32 v87, v38, v39
    buffer_store_dwordx4 v[84:87], v6, s[16:19], s36 offen sc1
.L_end:
    s_endpgm
.L_helper:
    s_setprio 3
    s_memrealtime s[54:55]
    v_lshlrev_b32 v3, 4, v2
    v_mov_b32 v1, 0
    s_waitcnt lgkmcnt(0)
    s_or_b32 s54, s54, 1
    s_mov_b32 s12, s8
    s_mov_b32 s13, s9
    s_mov_b32 s14, 13631488
    s_mov_b32 s15, 0x00020000
    s_mov_b32 s16, s50
    s_mov_b32 s17, s51
    s_mov_b32 s18, 256
    s_mov_b32 s19, 0x00020000
    v_mov_b32 v4, s54
    v_mov_b32 v5, s55
    s_cmp_lg_u32 s2, 0
    s_cbranch_scc1 .L_h_notok
    s_mov_b64 exec, 1
    buffer_store_dwordx2 v[4:5], v1, s[16:19], 0 offen sc1
    s_mov_b64 exec, -1
.L_h_notok:
    v_mov_b32 v17, 143360
    v_and_b32 v18, 3, v2
    v_lshlrev_b32 v18, 3, v18
    s_cmp_eq_u32 s22, 0
    s_cselect_b32 s4, s40, s46
    s_cselect_b32 s5, s41, s47
    s_mov_b32 s6, 524288
    s_mov_b32 s7, 0x00020000
    s_barrier
    s_barrier
    s_barrier
    s_barrier
    buffer_load_dwordx2 v[4:5], v1, s[16:19], 0 offen sc1
    s_barrier
    s_barrier
    s_barrier
    s_barrier
    s_mov_b32 s35, 0
.L_h_tok:
    s_waitcnt vmcnt(0)
    v_readfirstlane_b32 s52, v4
    v_readfirstlane_b32 s53, v5
    s_add_u32 s35, s35, 1
    s_cmp_gt_u32 s35, 1048576
    s_cbranch_scc1 .L_h_tokdone
    s_cmp_lg_u32 s52, 0
    s_cbranch_scc1 .L_h_tokdone
    buffer_load_dwordx2 v[4:5], v1, s[16:19], 0 offen sc1
    s_branch .L_h_tok
.L_h_tokdone:
    s_mov_b64 exec, 1
    ds_write_b64 v17, v[4:5]
    s_waitcnt lgkmcnt(0)
    s_barrier
    s_mov_b64 exec, -1
    s_mov_b32 s41, 1
    s_mov_b32 s40, 32768
    v_bfe_u32 v19, v2, 2, 3
    v_lshl_add_u32 v19, v19, 7, v18
    s_mov_b32 s56, 0
    s_mov_b32 s57, 0x11111111
    s_lshl_b32 s20, s24, 2
    s_bitset0_b32 s57, s20
.L_h_loop:
    s_cmp_eq_u32 s41, 2
    s_cbranch_scc0 .L_h_noclr
    s_lshl_b32 s20, s22, 3
    s_add_u32 s20, s20, s24
    s_lshl_b32 s20, s20, 18
    s_lshl_b32 s21, s25, 11
    s_add_u32 s20, s20, s21
    s_add_u32 s20, s20, 8388608
    v_mov_b32 v8, -1
    v_mov_b32 v9, -1
    v_mov_b32 v10, -1
    v_mov_b32 v11, -1
    s_mov_b32 s21, 0
.L_h_clr:
    buffer_store_dwordx4 v[8:11], v3, s[12:15], s20 offen sc1
    buffer_store_dwordx4 v[8:11], v3, s[12:15], s20 offen offset:1024 sc1
    s_add_u32 s20, s20, 32768
    s_add_u32 s21, s21, 1
    s_cmp_lt_u32 s21, 8
    s_cbranch_scc1 .L_h_clr
.L_h_noclr:
    s_cmp_eq_u32 s41, 3
    s_cbranch_scc0 .L_h_noclf
    s_lshl_b32 s21, s26, 3
    s_add_u32 s21, s21, s24
    s_lshl_b32 s21, s21, 7
    s_add_u32 s21, s21, 12582912
    s_mov_b64 exec, 1
    buffer_store_dwordx2 v[4:5], v1, s[12:15], s21 offen offset:32 sc1
    s_mov_b64 exec, -1
.L_h_noclf:
    s_mov_b32 s35, 0
    s_lshl_b32 s21, s26, 10
    s_add_u32 s21, s21, 12582912
.L_h_poll:
    s_and_b32 s20, s56, s57
    s_cbranch_scc1 .L_h_pick
    buffer_load_dwordx2 v[20:21], v19, s[12:15], s21 offen sc1
    s_add_u32 s35, s35, 1
    s_waitcnt vmcnt(0)
    v_cmp_eq_u64 vcc, s[52:53], v[20:21]
    s_cmp_gt_u32 s35, 1048576
    s_cselect_b32 s56, -1, vcc_lo
    s_lshr_b32 s20, s56, 1
    s_and_b32 s56, s56, s20
    s_lshr_b32 s20, s56, 2
    s_and_b32 s56, s56, s20
    s_branch .L_h_poll
.L_h_pick:
    s_lshl_b32 s30, s24, 2
    s_lshr_b32 s31, s20, s30
    s_lshl_b32 s31, s31, s30
    s_cmp_lg_u32 s31, 0
    s_cselect_b32 s20, s31, s20
    s_ff1_i32_b32 s20, s20
    s_bitset0_b32 s57, s20
    s_lshr_b32 s20, s20, 2
.L_h_go:
    s_lshl_b32 s30, s26, 17
    s_lshl_b32 s31, s20, 13
    s_add_u32 s30, s30, s31
    s_mov_b32 s33, s40
    s_add_u32 s34, s40, 16384
    s_mov_b32 s32, 0
.L_h_grp:
    s_mov_b32 m0, s33
    s_add_u32 s31, s30, 4194304
    buffer_load_dwordx4 v3, s[12:15], s30 offen offset:0 sc1 lds
    buffer_load_dwordx4 v3, s[12:15], s30 offen offset:1024 sc1 lds
    buffer_load_dwordx4 v3, s[12:15], s30 offen offset:2048 sc1 lds
    buffer_load_dwordx4 v3, s[12:15], s30 offen offset:3072 sc1 lds
    s_add_u32 m0, s34, 0
    s_nop 0
    buffer_load_dwordx4 v3, s[12:15], s31 offen offset:0 sc1 lds
    buffer_load_dwordx4 v3, s[12:15], s31 offen offset:1024 sc1 lds
    buffer_load_dwordx4 v3, s[12:15], s31 offen offset:2048 sc1 lds
    buffer_load_dwordx4 v3, s[12:15], s31 offen offset:3072 sc1 lds
    s_add_u32 s33, s33, 4096
    s_add_u32 s34, s34, 4096
    s_add_u32 s32, s32, 1
    s_cmp_eq_u32 s32, 2
    s_mov_b32 s31, 4096
    s_cselect_b32 s31, 61440, s31
    s_add_u32 s30, s30, s31
    s_cmp_lt_u32 s32, 4
    s_cbranch_scc1 .L_h_grp
    s_add_u32 s40, s40, 32768
    s_cmp_eq_u32 s40, 98304
    s_cselect_b32 s40, 0, s40
    s_add_u32 s41, s41, 1
    s_cmp_eq_u32 s41, 8
    s_cbranch_scc0 .L_h_go2
    v_and_b32 v18, 15, v2
    v_lshlrev_b32 v18, 10, v18
    s_lshl_b32 s21, s22, 7
    s_add_u32 s21, s21, s24
    s_lshl_b32 s21, s21, 7
    s_add_u32 s21, s21, 12582912
    s_mov_b32 s35, 0
.L_h_poll2:
    buffer_load_dwordx2 v[20:21], v18, s[12:15], s21 offen offset:32 sc1
    s_add_u32 s35, s35, 1
    s_waitcnt vmcnt(0)
    v_cmp_ne_u64 vcc, s[52:53], v[20:21]
    s_cmp_gt_u32 s35, 1048576
    s_cbranch_scc1 .L_h_go2
    s_cbranch_vccnz .L_h_poll2
.L_h_go2:
    s_waitcnt vmcnt(0) lgkmcnt(0)
    s_barrier
    s_cmp_lt_u32 s41, 8
    s_cbranch_scc1 .L_h_loop
    v_lshrrev_b32 v4, 3, v2
    v_and_b32 v5, 7, v2
    v_bfe_u32 v6, v2, 4, 1
    v_lshlrev_b32 v6, 2, v6
    v_xor_b32 v5, v5, v6
    v_lshlrev_b32 v5, 4, v5
    v_lshl_add_u32 v5, v4, 10, v5
    v_add_u32 v6, 7168, v5
    v_add_u32 v7, 14336, v5
    v_add_u32 v8, 21504, v5
    s_lshr_b32 s30, s25, 1
    s_lshl_b32 s30, s30, 7
    s_mov_b32 s33, 98304
.L_h_wo:
    s_mov_b32 m0, s33
    s_add_u32 s33, s33, 4096
    buffer_load_dwordx4 v5, s[4:7], s30 offen offset:0 lds
    buffer_load_dwordx4 v6, s[4:7], s30 offen offset:1024 lds
    buffer_load_dwordx4 v7, s[4:7], s30 offen offset:2048 lds
    buffer_load_dwordx4 v8, s[4:7], s30 offen offset:3072 lds
    s_add_u32 s30, s30, 32768
    s_waitcnt vmcnt(40)
    s_cmp_lt_u32 s33, 163840
    s_cbranch_scc1 .L_h_wo
    s_waitcnt vmcnt(0)
    s_barrier
    s_endpgm
.L_fallback:
    s_lshl_b32 s32, s54, 16
    s_mov_b32 s41, 0
    s_mov_b32 s37, 0
    s_waitcnt vmcnt(0)
    v_mov_b32 v64, 0xff800000
    v_mov_b32 v65, 0xff800000
.L_fb1:
    buffer_load_dwordx4 v[8:11], v3, s[12:15], s32 offen sc1
    s_add_u32 s32, s32, 1024
    s_waitcnt vmcnt(0)
    v_mfma_f32_32x32x16_bf16 v[80:95], v[8:11], v[152:155], 0
    v_mfma_f32_32x32x16_bf16 v[96:111], v[8:11], v[156:159], 0
    s_nop 15
    v_max3_f32 v64, v64, v80, v81
    v_max3_f32 v64, v64, v82, v83
    v_max3_f32 v64, v64, v84, v85
    v_max3_f32 v64, v64, v86, v87
    v_max3_f32 v64, v64, v88, v89
    v_max3_f32 v64, v64, v90, v91
    v_max3_f32 v64, v64, v92, v93
    v_max3_f32 v64, v64, v94, v95
    v_max3_f32 v65, v65, v96, v97
    v_max3_f32 v65, v65, v98, v99
    v_max3_f32 v65, v65, v100, v101
    v_max3_f32 v65, v65, v102, v103
    v_max3_f32 v65, v65, v104, v105
    v_max3_f32 v65, v65, v106, v107
    v_max3_f32 v65, v65, v108, v109
    v_max3_f32 v65, v65, v110, v111
    s_add_u32 s41, s41, 1
    s_cmp_lt_u32 s41, 64
    s_cbranch_scc1 .L_fb1
    v_mov_b32 v66, v64
    s_nop 1
    v_permlane32_swap_b32 v64, v66
    s_nop 1
    v_min_f32 v80, -v64, -v66
    v_min_f32 v81, -v64, -v66
    v_pk_mov_b32 v[82:83], v[80:81], v[80:81] op_sel:[0,1]
    v_pk_mov_b32 v[84:85], v[80:81], v[80:81] op_sel:[0,1]
    v_pk_mov_b32 v[86:87], v[80:81], v[80:81] op_sel:[0,1]
    v_pk_mov_b32 v[88:89], v[80:81], v[80:81] op_sel:[0,1]
    v_pk_mov_b32 v[90:91], v[80:81], v[80:81] op_sel:[0,1]
    v_pk_mov_b32 v[92:93], v[80:81], v[80:81] op_sel:[0,1]
    v_pk_mov_b32 v[94:95], v[80:81], v[80:81] op_sel:[0,1]
    v_mov_b32 v67, v65
    s_nop 1
    v_permlane32_swap_b32 v65, v67
    s_nop 1
    v_min_f32 v96, -v65, -v67
    v_min_f32 v97, -v65, -v67
    v_pk_mov_b32 v[98:99], v[96:97], v[96:97] op_sel:[0,1]
    v_pk_mov_b32 v[100:101], v[96:97], v[96:97] op_sel:[0,1]
    v_pk_mov_b32 v[102:103], v[96:97], v[96:97] op_sel:[0,1]
    v_pk_mov_b32 v[104:105], v[96:97], v[96:97] op_sel:[0,1]
    v_pk_mov_b32 v[106:107], v[96:97], v[96:97] op_sel:[0,1]
    v_pk_mov_b32 v[108:109], v[96:97], v[96:97] op_sel:[0,1]
    v_pk_mov_b32 v[110:111], v[96:97], v[96:97] op_sel:[0,1]
    v_mov_b32 v112, 0
    v_mov_b32 v113, 0
    v_mov_b32 v114, 0
    v_mov_b32 v115, 0
    v_mov_b32 v116, 0
    v_mov_b32 v117, 0
    v_mov_b32 v118, 0
    v_mov_b32 v119, 0
    v_mov_b32 v120, 0
    v_mov_b32 v121, 0
    v_mov_b32 v122, 0
    v_mov_b32 v123, 0
    v_mov_b32 v124, 0
    v_mov_b32 v125, 0
    v_mov_b32 v126, 0
    v_mov_b32 v127, 0
    v_mov_b32 v128, 0
    v_mov_b32 v129, 0
    v_mov_b32 v130, 0
    v_mov_b32 v131, 0
    v_mov_b32 v132, 0
    v_mov_b32 v133, 0
    v_mov_b32 v134, 0
    v_mov_b32 v135, 0
    v_mov_b32 v136, 0
    v_mov_b32 v137, 0
    v_mov_b32 v138, 0
    v_mov_b32 v139, 0
    v_mov_b32 v140, 0
    v_mov_b32 v141, 0
    v_mov_b32 v142, 0
    v_mov_b32 v143, 0
    v_mov_b32 v16, 0x3f803f80
    v_mov_b32 v24, 0x3f803f80
    v_mov_b32 v17, 0x3f803f80
    v_mov_b32 v25, 0x3f803f80
    v_mov_b32 v18, 0x3f803f80
    v_mov_b32 v26, 0x3f803f80
    v_mov_b32 v19, 0x3f803f80
    v_mov_b32 v27, 0x3f803f80
    v_and_b32 v72, 15, v2
    v_lshlrev_b32 v72, 4, v72
    v_lshrrev_b32 v73, 5, v2
    v_lshl_add_u32 v72, v73, 8, v72
    s_lshl_b32 s32, s54, 16
    s_mov_b32 s41, 0
    s_mov_b32 s46, 0x0000ffff
    s_mov_b32 s47, 0x0000ffff
.L_fb2:
    s_add_u32 s33, s32, 4194304
    buffer_load_dwordx4 v[8:11], v3, s[12:15], s32 offen sc1
    s_mov_b64 exec, s[46:47]
    buffer_load_dwordx4 v[16:19], v72, s[12:15], s33 offen sc1
    buffer_load_dwordx4 v[24:27], v72, s[12:15], s33 offen offset:512 sc1
    s_mov_b64 exec, -1
    s_add_u32 s32, s32, 1024
    s_waitcnt vmcnt(0)
    v_mfma_f32_32x32x16_bf16 v[32:47], v[8:11], v[152:155], v[80:95]
    v_mfma_f32_32x32x16_bf16 v[48:63], v[8:11], v[156:159], v[96:111]
    s_nop 15
    v_exp_f32 v32, v32
    v_exp_f32 v33, v33
    v_exp_f32 v34, v34
    v_exp_f32 v35, v35
    v_exp_f32 v36, v36
    v_exp_f32 v37, v37
    v_exp_f32 v38, v38
    v_exp_f32 v39, v39
    v_exp_f32 v40, v40
    v_exp_f32 v41, v41
    v_exp_f32 v42, v42
    v_exp_f32 v43, v43
    v_exp_f32 v44, v44
    v_exp_f32 v45, v45
    v_exp_f32 v46, v46
    v_exp_f32 v47, v47
    v_exp_f32 v48, v48
    v_exp_f32 v49, v49
    v_exp_f32 v50, v50
    v_exp_f32 v51, v51
    v_exp_f32 v52, v52
    v_exp_f32 v53, v53
    v_exp_f32 v54, v54
    v_exp_f32 v55, v55
    v_exp_f32 v56, v56
    v_exp_f32 v57, v57
    v_exp_f32 v58, v58
    v_exp_f32 v59, v59
    v_exp_f32 v60, v60
    v_exp_f32 v61, v61
    v_exp_f32 v62, v62
    v_exp_f32 v63, v63
    s_nop 1
    v_smfmac_f32_32x32x32_bf16 v[112:127], v[16:19], v[32:39], v7
    v_smfmac_f32_32x32x32_bf16 v[112:127], v[24:27], v[40:47], v7
    v_smfmac_f32_32x32x32_bf16 v[128:143], v[16:19], v[48:55], v7
    v_smfmac_f32_32x32x32_bf16 v[128:143], v[24:27], v[56:63], v7
    s_add_u32 s41, s41, 1
    s_cmp_lt_u32 s41, 64
    s_nop 15
    s_cbranch_scc1 .L_fb2
    s_cmp_lg_u64 s[44:45], 0
    s_cbranch_scc0 .L_fb3
    v_rcp_f32 v68, v120
    s_nop 0
    v_mul_f32 v112, v112, v68
    v_mul_f32 v113, v113, v68
    v_mul_f32 v114, v114, v68
    v_mul_f32 v115, v115, v68
    v_mul_f32 v116, v116, v68
    v_mul_f32 v117, v117, v68
    v_mul_f32 v118, v118, v68
    v_mul_f32 v119, v119, v68
    v_cvt_pk_bf16_f32 v148, v112, v113
    v_cvt_pk_bf16_f32 v149, v114, v115
    v_cvt_pk_bf16_f32 v150, v116, v117
    v_cvt_pk_bf16_f32 v151, v118, v119
    v_min_u32 v148, -2, v148
    v_min_u32 v149, -2, v149
    v_min_u32 v150, -2, v150
    v_min_u32 v151, -2, v151
    buffer_store_dwordx4 v[148:151], v3, s[12:15], s55 offen sc1
.L_fb3:
    v_rcp_f32 v68, v136
    s_nop 0
    v_mul_f32 v128, v128, v68
    v_mul_f32 v129, v129, v68
    v_mul_f32 v130, v130, v68
    v_mul_f32 v131, v131, v68
    v_mul_f32 v132, v132, v68
    v_mul_f32 v133, v133, v68
    v_mul_f32 v134, v134, v68
    v_mul_f32 v135, v135, v68
    v_cvt_pk_bf16_f32 v32, v128, v129
    v_cvt_pk_bf16_f32 v33, v130, v131
    v_cvt_pk_bf16_f32 v34, v132, v133
    v_cvt_pk_bf16_f32 v35, v134, v135
    v_min_u32 v32, -2, v32
    v_min_u32 v33, -2, v33
    v_min_u32 v34, -2, v34
    v_min_u32 v35, -2, v35
    buffer_store_dwordx4 v[32:35], v3, s[12:15], s59 offen sc1
    s_branch .L_final
.section .rodata,"a"
.p2align 6
.amdhsa_kernel concat_heads__softmax_full_mha__softmax_full_mha__prompt_kernel
  .amdhsa_next_free_vgpr 160
  .amdhsa_next_free_sgpr 102
  .amdhsa_accum_offset 160
  .amdhsa_group_segment_fixed_size 0
  .amdhsa_kernarg_size 72
  .amdhsa_user_sgpr_count 2
  .amdhsa_user_sgpr_kernarg_segment_ptr 1
  .amdhsa_system_sgpr_workgroup_id_x 1
.end_amdhsa_kernel
```
